```python
import torch

def _softmax(x, axis=-1):
    return torch.softmax(x, dim=axis)
def _gelu(x):
    return torch.nn.functional.gelu(x, approximate="tanh")
def _silu(x):
    return torch.nn.functional.silu(x)
def _sigmoid(x):
    return torch.sigmoid(x)
def _layernorm(x, axis=-1, eps=1e-5):
    m = x.mean(dim=axis, keepdim=True)
    v = x.var(dim=axis, keepdim=True, unbiased=False)
    return (x - m) / torch.sqrt(v + eps)
def _scatter_add(tgt, idx, src, axis=0):
    return tgt.clone().index_add_(axis, idx, src)
def _segment_sum(src, seg, n):
    out = torch.zeros((n,) + src.shape[1:], dtype=src.dtype)
    return out.index_add_(0, seg, src)
def _pad(x, pw):
    flat = tuple(v for pair in reversed(pw) for v in pair)
    return torch.nn.functional.pad(x, flat)

kernel_name = 'concat_heads__sliding_local_dilated__softmax_full_mha__prompt'

def setup_inputs():

    _w = (lambda a: (lambda t: t.to(torch.bfloat16) if t.is_floating_point() else t)(torch.as_tensor(a)))
    def _A_setup():
        B, S, D = 1, 2048, 448
        return {
            "x": _w((lambda *s: torch.randn(*s, dtype=torch.bfloat16) * 0.4)(B, S, D)),
            "wqkv": _w((lambda *s: torch.randn(*s, dtype=torch.bfloat16) * 0.8)(D, 3 * D)),
            "wo": _w((lambda *s: torch.randn(*s, dtype=torch.bfloat16) * 0.1)(D, D)),
        }
    _A_in = _A_setup()

    def _B_setup():
        B, S, D = 1, 2048, 448
        return {
            "x": _w((lambda *s: torch.randn(*s, dtype=torch.bfloat16) * 0.2)(B, S, D)),
            "wqkv": _w((lambda *s: torch.randn(*s, dtype=torch.bfloat16) * 0.8)(D, 3 * D)),
            "wo": _w((lambda *s: torch.randn(*s, dtype=torch.bfloat16) * 0.2)(D, D)),
        }
    _B_in = _B_setup()

    return {
        "A_x": _A_in["x"],
        "A_wqkv": _A_in["wqkv"],
        "A_wo": _A_in["wo"],
        "B_x": _B_in["x"],
        "B_wqkv": _B_in["wqkv"],
        "B_wo": _B_in["wo"],
    }

def reference(A_x, A_wqkv, A_wo, B_x, B_wqkv, B_wo):
    def _A_ref(x, wqkv, wo):
        B, S, D = x.shape
        H = 16; Dh = D // H
        W, dil = 8, 2
        qkv = (lambda x, *d: x.permute(*d))((x @ wqkv).reshape(B, S, 3, H, Dh), 2, 0, 3, 1, 4)
        q, k, v = qkv[0], qkv[1], qkv[2]
        scale = Dh ** -0.5
        pos = torch.arange(S)
        off = torch.arange(W) * dil
        idx = pos[:, None] - off[None, :]
        mask = idx >= 0
        idx_c = torch.where(mask, idx, 0).reshape(-1)
        kg = k[:, :, idx_c, :].reshape(B, H, S, W, Dh)
        vg = v[:, :, idx_c, :].reshape(B, H, S, W, Dh)
        logits = torch.einsum("bhsd,bhswd->bhsw", q, kg) * scale
        logits = torch.where(mask[None, None, :, :], logits, -1e9)
        attn = _softmax(logits, axis=-1)
        o = torch.einsum("bhsw,bhswd->bhsd", attn, vg)
        return (lambda x, *d: x.permute(*d))(o, 0, 2, 1, 3).reshape(B, S, D) @ wo

    def _B_ref(x, wqkv, wo):
        B, S, D = x.shape
        H = 16; Dh = D // H
        qkv = (lambda x, *d: x.permute(*d))((x @ wqkv).reshape(B, S, 3, H, Dh), 2, 0, 3, 1, 4)
        q, k, v = qkv[0], qkv[1], qkv[2]
        scale = Dh ** -0.5
        scores = torch.einsum("bhqd,bhkd->bhqk", q, k) * scale
        p = _softmax(scores, axis=-1)
        o = torch.einsum("bhqk,bhkd->bhqd", p, v)
        return (lambda x, *d: x.permute(*d))(o, 0, 2, 1, 3).reshape(B, S, D) @ wo

    a = _A_ref(A_x, A_wqkv, A_wo)
    b = _B_ref(B_x, B_wqkv, B_wo)
    return torch.concatenate([a, b], axis=-1)
```

```asm
; @launch kernel=qkv_kernel grid=(256,1,1) block=(768,1,1) lds=151616
; @launch kernel=attn_kernel grid=(256,1,1) block=(512,1,1) lds=163840
.amdgcn_target "amdgcn-amd-amdhsa--gfx950"
.text
.globl qkv_kernel
.p2align 8
.type qkv_kernel,@function
qkv_kernel:
    s_cmp_ge_u32 s2, 256
    s_cbranch_scc1 L_k1_end
    s_load_dwordx4 s[32:35], s[0:1], 0
    s_load_dwordx4 s[36:39], s[0:1], 24
    s_load_dwordx2 s[16:17], s[0:1], 64
    v_lshrrev_b32 v1, 6, v0
    v_and_b32 v0, 63, v0
    v_readfirstlane_b32 s6, v1
    s_lshr_b32 s23, s2, 3
    s_bfe_u32 s3, s2, 0x10002
    s_bfe_u32 s25, s2, 0x10001
    s_lshl_b32 s25, s25, 3
    s_and_b32 s26, s23, 7
    s_add_u32 s4, s25, s26
    s_and_b32 s25, s2, 1
    s_lshl_b32 s25, s25, 2
    s_lshr_b32 s26, s23, 3
    s_add_u32 s5, s25, s26
    s_cmp_ge_u32 s6, 4
    s_cbranch_scc1 L_k1_compute
    s_lshl_b32 s24, s6, 5
    s_lshr_b32 s25, s6, 1
    s_lshl_b32 s25, s25, 6
    s_and_b32 s26, s6, 1
    s_add_u32 s25, s25, s26
    s_cmp_eq_u32 s3, 0
    s_cselect_b32 s24, s25, s24
    s_sub_u32 s25, 1, s3
    s_lshl_b32 s45, 896, s25
    s_lshl_b32 s25, s4, 7
    s_add_u32 s24, s24, s25
    s_mul_i32 s24, s24, 896
    v_lshrrev_b32 v8, 3, v0
    v_mul_lo_u32 v9, v8, s45
    v_add_u32 v9, s24, v9
    v_and_b32 v6, 7, v0
    v_lshrrev_b32 v7, 4, v0
    v_xor_b32 v8, v6, v7
    v_lshl_add_u32 v2, v8, 4, v9
    v_xor_b32 v8, 4, v8
    v_lshl_add_u32 v3, v8, 4, v9
    s_lshl_b32 s25, s45, 3
    v_add_u32 v3, s25, v3
    s_lshl_b32 s25, s45, 4
    v_add_u32 v4, s25, v2
    v_add_u32 v5, s25, v3
    s_lshl_b32 s20, s6, 12
    s_mul_i32 s21, s6, 5376
    s_mul_i32 s25, s5, 336
    s_mul_i32 s26, s6, 43008
    s_add_u32 s25, s25, s26
    s_movk_i32 s42, 3121
    s_movk_i32 s43, 2688
    s_waitcnt lgkmcnt(0)
    s_cmp_eq_u32 s3, 0
    s_cselect_b32 s8, s32, s36
    s_cselect_b32 s9, s33, s37
    s_cselect_b32 s12, s34, s38
    s_cselect_b32 s13, s35, s39
    s_and_b32 s9, s9, 0xffff
    s_mov_b32 s10, 1835008
    s_mov_b32 s11, 0x20000
    s_add_u32 m0, s20, 0
    s_nop 0
    buffer_load_dwordx4 v2, s[8:11], 0 offen lds
    s_add_u32 m0, s20, 1024
    s_nop 0
    buffer_load_dwordx4 v3, s[8:11], 0 offen lds
    s_add_u32 m0, s20, 2048
    s_nop 0
    buffer_load_dwordx4 v4, s[8:11], 0 offen lds
    s_add_u32 m0, s20, 3072
    s_nop 0
    buffer_load_dwordx4 v5, s[8:11], 0 offen lds
    s_and_b32 s13, s13, 0xffff
    s_mov_b32 s14, 1204224
    s_mov_b32 s15, 0x20000
    v_mul_u32_u24 v17, s42, v0
    v_lshrrev_b32 v17, 16, v17
    v_mul_u32_u24 v18, 21, v17
    v_sub_u32 v18, v0, v18
    v_and_b32 v21, 3, v17
    v_lshrrev_b32 v17, 2, v17
    v_lshl_add_u32 v21, v21, 2, v17
    v_mul_u32_u24 v21, s43, v21
    v_lshl_add_u32 v21, v18, 4, v21
    v_add_u32 v10, s25, v21
    s_add_u32 m0, s21, 16384
    s_nop 0
    buffer_load_dwordx4 v10, s[12:15], 0 offen lds
    v_add_u32 v16, 64, v0
    v_mul_u32_u24 v17, s42, v16
    v_lshrrev_b32 v17, 16, v17
    v_mul_u32_u24 v18, 21, v17
    v_sub_u32 v18, v16, v18
    v_and_b32 v21, 3, v17
    v_lshrrev_b32 v17, 2, v17
    v_lshl_add_u32 v21, v21, 2, v17
    v_mul_u32_u24 v21, s43, v21
    v_lshl_add_u32 v21, v18, 4, v21
    v_add_u32 v11, s25, v21
    s_add_u32 m0, s21, 17408
    s_nop 0
    buffer_load_dwordx4 v11, s[12:15], 0 offen lds
    v_add_u32 v16, 128, v0
    v_mul_u32_u24 v17, s42, v16
    v_lshrrev_b32 v17, 16, v17
    v_mul_u32_u24 v18, 21, v17
    v_sub_u32 v18, v16, v18
    v_and_b32 v21, 3, v17
    v_lshrrev_b32 v17, 2, v17
    v_lshl_add_u32 v21, v21, 2, v17
    v_mul_u32_u24 v21, s43, v21
    v_lshl_add_u32 v21, v18, 4, v21
    v_add_u32 v12, s25, v21
    s_add_u32 m0, s21, 18432
    s_nop 0
    buffer_load_dwordx4 v12, s[12:15], 0 offen lds
    v_add_u32 v16, 192, v0
    v_mul_u32_u24 v17, s42, v16
    v_lshrrev_b32 v17, 16, v17
    v_mul_u32_u24 v18, 21, v17
    v_sub_u32 v18, v16, v18
    v_and_b32 v21, 3, v17
    v_lshrrev_b32 v17, 2, v17
    v_lshl_add_u32 v21, v21, 2, v17
    v_mul_u32_u24 v21, s43, v21
    v_lshl_add_u32 v21, v18, 4, v21
    v_add_u32 v13, s25, v21
    s_add_u32 m0, s21, 19456
    s_nop 0
    buffer_load_dwordx4 v13, s[12:15], 0 offen lds
    v_add_u32 v16, 256, v0
    v_mul_u32_u24 v17, s42, v16
    v_lshrrev_b32 v17, 16, v17
    v_mul_u32_u24 v18, 21, v17
    v_sub_u32 v18, v16, v18
    v_and_b32 v21, 3, v17
    v_lshrrev_b32 v17, 2, v17
    v_lshl_add_u32 v21, v21, 2, v17
    v_mul_u32_u24 v21, s43, v21
    v_lshl_add_u32 v21, v18, 4, v21
    v_add_u32 v14, s25, v21
    s_add_u32 m0, s21, 20480
    s_nop 0
    buffer_load_dwordx4 v14, s[12:15], 0 offen lds
    v_add_u32 v16, 320, v0
    v_mul_u32_u24 v17, s42, v16
    v_lshrrev_b32 v17, 16, v17
    v_mul_u32_u24 v18, 21, v17
    v_sub_u32 v18, v16, v18
    v_and_b32 v21, 3, v17
    v_lshrrev_b32 v17, 2, v17
    v_lshl_add_u32 v21, v21, 2, v17
    v_mul_u32_u24 v21, s43, v21
    v_lshl_add_u32 v21, v18, 4, v21
    v_add_u32 v15, s25, v21
    s_add_u32 m0, s21, 21504
    s_mov_b64 exec, 0xffff
    buffer_load_dwordx4 v15, s[12:15], 0 offen lds
    s_mov_b64 exec, -1
    s_movk_i32 s27, 128
    s_add_u32 m0, s20, 37888
    s_nop 0
    buffer_load_dwordx4 v2, s[8:11], s27 offen lds
    s_add_u32 m0, s20, 38912
    s_nop 0
    buffer_load_dwordx4 v3, s[8:11], s27 offen lds
    s_add_u32 m0, s20, 39936
    s_nop 0
    buffer_load_dwordx4 v4, s[8:11], s27 offen lds
    s_add_u32 m0, s20, 40960
    s_nop 0
    buffer_load_dwordx4 v5, s[8:11], s27 offen lds
    s_mov_b32 s28, 172032
    s_add_u32 m0, s21, 54272
    s_nop 0
    buffer_load_dwordx4 v10, s[12:15], s28 offen lds
    s_add_u32 m0, s21, 55296
    s_nop 0
    buffer_load_dwordx4 v11, s[12:15], s28 offen lds
    s_add_u32 m0, s21, 56320
    s_nop 0
    buffer_load_dwordx4 v12, s[12:15], s28 offen lds
    s_add_u32 m0, s21, 57344
    s_nop 0
    buffer_load_dwordx4 v13, s[12:15], s28 offen lds
    s_add_u32 m0, s21, 58368
    s_nop 0
    buffer_load_dwordx4 v14, s[12:15], s28 offen lds
    s_add_u32 m0, s21, 59392
    s_mov_b64 exec, 0xffff
    buffer_load_dwordx4 v15, s[12:15], s28 offen lds
    s_mov_b64 exec, -1
    s_waitcnt vmcnt(10)
    s_barrier
    s_movk_i32 s27, 256
    s_add_u32 m0, s20, 75776
    s_nop 0
    buffer_load_dwordx4 v2, s[8:11], s27 offen lds
    s_add_u32 m0, s20, 76800
    s_nop 0
    buffer_load_dwordx4 v3, s[8:11], s27 offen lds
    s_add_u32 m0, s20, 77824
    s_nop 0
    buffer_load_dwordx4 v4, s[8:11], s27 offen lds
    s_add_u32 m0, s20, 78848
    s_nop 0
    buffer_load_dwordx4 v5, s[8:11], s27 offen lds
    s_mov_b32 s28, 344064
    s_add_u32 m0, s21, 92160
    s_nop 0
    buffer_load_dwordx4 v10, s[12:15], s28 offen lds
    s_add_u32 m0, s21, 93184
    s_nop 0
    buffer_load_dwordx4 v11, s[12:15], s28 offen lds
    s_add_u32 m0, s21, 94208
    s_nop 0
    buffer_load_dwordx4 v12, s[12:15], s28 offen lds
    s_add_u32 m0, s21, 95232
    s_nop 0
    buffer_load_dwordx4 v13, s[12:15], s28 offen lds
    s_add_u32 m0, s21, 96256
    s_nop 0
    buffer_load_dwordx4 v14, s[12:15], s28 offen lds
    s_add_u32 m0, s21, 97280
    s_mov_b64 exec, 0xffff
    buffer_load_dwordx4 v15, s[12:15], s28 offen lds
    s_mov_b64 exec, -1
    s_waitcnt vmcnt(10)
    s_barrier
    s_movk_i32 s27, 384
    s_add_u32 m0, s20, 113664
    s_nop 0
    buffer_load_dwordx4 v2, s[8:11], s27 offen lds
    s_add_u32 m0, s20, 114688
    s_nop 0
    buffer_load_dwordx4 v3, s[8:11], s27 offen lds
    s_add_u32 m0, s20, 115712
    s_nop 0
    buffer_load_dwordx4 v4, s[8:11], s27 offen lds
    s_add_u32 m0, s20, 116736
    s_nop 0
    buffer_load_dwordx4 v5, s[8:11], s27 offen lds
    s_mov_b32 s28, 516096
    s_add_u32 m0, s21, 130048
    s_nop 0
    buffer_load_dwordx4 v10, s[12:15], s28 offen lds
    s_add_u32 m0, s21, 131072
    s_nop 0
    buffer_load_dwordx4 v11, s[12:15], s28 offen lds
    s_add_u32 m0, s21, 132096
    s_nop 0
    buffer_load_dwordx4 v12, s[12:15], s28 offen lds
    s_add_u32 m0, s21, 133120
    s_nop 0
    buffer_load_dwordx4 v13, s[12:15], s28 offen lds
    s_add_u32 m0, s21, 134144
    s_nop 0
    buffer_load_dwordx4 v14, s[12:15], s28 offen lds
    s_add_u32 m0, s21, 135168
    s_mov_b64 exec, 0xffff
    buffer_load_dwordx4 v15, s[12:15], s28 offen lds
    s_mov_b64 exec, -1
    s_waitcnt vmcnt(10)
    s_barrier
    s_movk_i32 s27, 512
    s_add_u32 m0, s20, 0
    s_nop 0
    buffer_load_dwordx4 v2, s[8:11], s27 offen lds
    s_add_u32 m0, s20, 1024
    s_nop 0
    buffer_load_dwordx4 v3, s[8:11], s27 offen lds
    s_add_u32 m0, s20, 2048
    s_nop 0
    buffer_load_dwordx4 v4, s[8:11], s27 offen lds
    s_add_u32 m0, s20, 3072
    s_nop 0
    buffer_load_dwordx4 v5, s[8:11], s27 offen lds
    s_mov_b32 s28, 688128
    s_add_u32 m0, s21, 16384
    s_nop 0
    buffer_load_dwordx4 v10, s[12:15], s28 offen lds
    s_add_u32 m0, s21, 17408
    s_nop 0
    buffer_load_dwordx4 v11, s[12:15], s28 offen lds
    s_add_u32 m0, s21, 18432
    s_nop 0
    buffer_load_dwordx4 v12, s[12:15], s28 offen lds
    s_add_u32 m0, s21, 19456
    s_nop 0
    buffer_load_dwordx4 v13, s[12:15], s28 offen lds
    s_add_u32 m0, s21, 20480
    s_nop 0
    buffer_load_dwordx4 v14, s[12:15], s28 offen lds
    s_add_u32 m0, s21, 21504
    s_mov_b64 exec, 0xffff
    buffer_load_dwordx4 v15, s[12:15], s28 offen lds
    s_mov_b64 exec, -1
    s_waitcnt vmcnt(10)
    s_barrier
    s_movk_i32 s27, 640
    s_add_u32 m0, s20, 37888
    s_nop 0
    buffer_load_dwordx4 v2, s[8:11], s27 offen lds
    s_add_u32 m0, s20, 38912
    s_nop 0
    buffer_load_dwordx4 v3, s[8:11], s27 offen lds
    s_add_u32 m0, s20, 39936
    s_nop 0
    buffer_load_dwordx4 v4, s[8:11], s27 offen lds
    s_add_u32 m0, s20, 40960
    s_nop 0
    buffer_load_dwordx4 v5, s[8:11], s27 offen lds
    s_mov_b32 s28, 860160
    s_add_u32 m0, s21, 54272
    s_nop 0
    buffer_load_dwordx4 v10, s[12:15], s28 offen lds
    s_add_u32 m0, s21, 55296
    s_nop 0
    buffer_load_dwordx4 v11, s[12:15], s28 offen lds
    s_add_u32 m0, s21, 56320
    s_nop 0
    buffer_load_dwordx4 v12, s[12:15], s28 offen lds
    s_add_u32 m0, s21, 57344
    s_nop 0
    buffer_load_dwordx4 v13, s[12:15], s28 offen lds
    s_add_u32 m0, s21, 58368
    s_nop 0
    buffer_load_dwordx4 v14, s[12:15], s28 offen lds
    s_add_u32 m0, s21, 59392
    s_mov_b64 exec, 0xffff
    buffer_load_dwordx4 v15, s[12:15], s28 offen lds
    s_mov_b64 exec, -1
    s_movk_i32 s27, 768
    s_add_u32 m0, s20, 75776
    s_nop 0
    buffer_load_dwordx4 v2, s[8:11], s27 offen lds
    s_add_u32 m0, s20, 76800
    s_nop 0
    buffer_load_dwordx4 v3, s[8:11], s27 offen lds
    s_add_u32 m0, s20, 77824
    s_nop 0
    buffer_load_dwordx4 v4, s[8:11], s27 offen lds
    s_add_u32 m0, s20, 78848
    s_nop 0
    buffer_load_dwordx4 v5, s[8:11], s27 offen lds
    s_mov_b32 s28, 1032192
    s_add_u32 m0, s21, 92160
    s_nop 0
    buffer_load_dwordx4 v10, s[12:15], s28 offen lds
    s_add_u32 m0, s21, 93184
    s_nop 0
    buffer_load_dwordx4 v11, s[12:15], s28 offen lds
    s_add_u32 m0, s21, 94208
    s_nop 0
    buffer_load_dwordx4 v12, s[12:15], s28 offen lds
    s_add_u32 m0, s21, 95232
    s_nop 0
    buffer_load_dwordx4 v13, s[12:15], s28 offen lds
    s_add_u32 m0, s21, 96256
    s_nop 0
    buffer_load_dwordx4 v14, s[12:15], s28 offen lds
    s_add_u32 m0, s21, 97280
    s_mov_b64 exec, 0xffff
    buffer_load_dwordx4 v15, s[12:15], s28 offen lds
    s_mov_b64 exec, -1
    s_waitcnt vmcnt(20)
    s_barrier
    s_waitcnt vmcnt(10)
    s_barrier
    s_waitcnt vmcnt(0)
    s_barrier
    s_endpgm
L_k1_compute:
    s_sub_u32 s6, s6, 4
    s_and_b32 s22, s6, 3
    s_lshr_b32 s23, s6, 2
    v_and_b32 v4, 31, v0
    v_lshrrev_b32 v5, 5, v0
    v_bfe_u32 v6, v0, 1, 3
    s_lshl_b32 s24, s22, 12
    v_lshlrev_b32 v7, 7, v4
    v_add_u32 v7, s24, v7
    v_or_b32 v8, 0, v5
    v_xor_b32 v8, v8, v6
    v_lshl_add_u32 v16, v8, 4, v7
    v_add_u32 v20, 75776, v16
    v_or_b32 v8, 2, v5
    v_xor_b32 v8, v8, v6
    v_lshl_add_u32 v17, v8, 4, v7
    v_add_u32 v21, 75776, v17
    v_or_b32 v8, 4, v5
    v_xor_b32 v8, v8, v6
    v_lshl_add_u32 v18, v8, 4, v7
    v_add_u32 v22, 75776, v18
    v_or_b32 v8, 6, v5
    v_xor_b32 v8, v8, v6
    v_lshl_add_u32 v19, v8, 4, v7
    v_add_u32 v23, 75776, v19
    v_bfe_u32 v6, v0, 2, 2
    v_lshlrev_b32 v6, 2, v6
    v_lshl_add_u32 v6, v5, 1, v6
    v_mul_u32_u24 v6, 336, v6
    v_bfe_u32 v7, v0, 4, 1
    v_lshl_add_u32 v6, v7, 5, v6
    v_and_b32 v7, 3, v0
    v_lshl_add_u32 v6, v7, 3, v6
    s_mul_i32 s24, s23, 168
    s_add_u32 s24, s24, 16384
    v_add_u32 v24, s24, v6
    v_add_u32 v25, 75776, v24
    s_lshl_b32 s46, s5, 1
    s_add_u32 s46, s46, s23
    s_mul_i32 s47, s46, 3
    s_lshl_b32 s24, s47, 17
    s_lshl_b32 s25, s4, 2
    s_add_u32 s25, s25, s22
    s_lshl_b32 s25, s25, 11
    s_add_u32 s24, s24, s25
    s_mul_i32 s25, s3, 6291456
    s_add_u32 s29, s24, s25
    s_add_u32 s30, s29, 0x20000
    s_add_u32 s31, s29, 0x40000
    s_add_u32 s24, s47, 0
    s_cmp_lt_u32 s24, 16
    s_cselect_b32 s48, 0x3e8b97f6, 1.0
    s_cselect_b32 s51, 0, 0x3f80
    s_add_u32 s24, s47, 1
    s_cmp_lt_u32 s24, 16
    s_cselect_b32 s49, 0x3e8b97f6, 1.0
    s_cselect_b32 s52, 0, 0x3f80
    s_add_u32 s24, s47, 2
    s_cmp_lt_u32 s24, 16
    s_cselect_b32 s50, 0x3e8b97f6, 1.0
    s_cselect_b32 s53, 0, 0x3f80
    v_lshlrev_b32 v1, 4, v0
    s_mov_b32 s18, 16842752
    s_mov_b32 s19, 0x20000
    s_waitcnt lgkmcnt(0)
    s_and_b32 s17, s17, 0xffff
    s_cmp_lg_u32 s6, 0
    s_cbranch_scc1 L_k1_nf
    s_lshl_b32 s24, s2, 6
    s_add_u32 s24, s24, 16777216
    v_lshlrev_b32 v4, 2, v0
    v_mov_b32 v5, 0
    s_mov_b64 exec, 0xffff
    buffer_store_dword v5, v4, s[16:19], s24 offen
    s_mov_b64 exec, -1
L_k1_nf:
    s_cmp_lg_u32 s6, 1
    s_cbranch_scc1 L_k1_npf
    s_getpc_b64 s[60:61]
L_k1_pc:
    s_add_u32 s60, s60, attn_kernel - L_k1_pc
    s_addc_u32 s61, s61, 0
    s_lshr_b32 s24, s2, 3
    s_lshl_b32 s24, s24, 10
    v_lshlrev_b32 v4, 7, v0
    v_add_u32 v4, s24, v4
    v_cmp_gt_u32 vcc, L_k2_code_end - attn_kernel, v4
    s_and_b64 exec, vcc, 0xff
    s_cbranch_execz L_k1_npf2
    global_load_dword v27, v4, s[60:61]
L_k1_npf2:
    s_mov_b64 exec, -1
L_k1_npf:
    s_mov_b32 s54, s48
    s_mov_b32 s55, s48
    s_mov_b32 s56, s49
    s_mov_b32 s57, s49
    s_mov_b32 s58, s50
    s_mov_b32 s59, s50
    v_mov_b32 v26, 0
    s_mov_b32 exec_lo, 0x10000000
    s_mov_b32 exec_hi, 0x10000000
    v_mov_b32 v26, 0x3f803f80
    s_mov_b64 exec, -1
    s_cmp_gt_u32 s46, 10
    s_cbranch_scc1 L_k1_v
    s_cmp_eq_u32 s46, 10
    s_cbranch_scc1 L_k1_m
    s_barrier
    ds_read_b128 v[80:83], v16 offset:0
    ds_read_b64_tr_b16 v[88:89], v24 offset:0
    ds_read_b64_tr_b16 v[90:91], v24 offset:336
    ds_read_b64_tr_b16 v[92:93], v24 offset:56
    ds_read_b64_tr_b16 v[94:95], v24 offset:392
    ds_read_b64_tr_b16 v[96:97], v24 offset:112
    ds_read_b64_tr_b16 v[98:99], v24 offset:448
    ds_read_b128 v[84:87], v17 offset:0
    ds_read_b64_tr_b16 v[100:101], v24 offset:5376
    ds_read_b64_tr_b16 v[102:103], v24 offset:5712
    ds_read_b64_tr_b16 v[104:105], v24 offset:5432
    ds_read_b64_tr_b16 v[106:107], v24 offset:5768
    ds_read_b64_tr_b16 v[108:109], v24 offset:5488
    ds_read_b64_tr_b16 v[110:111], v24 offset:5824
    s_waitcnt lgkmcnt(7)
    v_mfma_f32_32x32x16_bf16 v[32:47], v[88:91], v[80:83], 0
    v_mfma_f32_32x32x16_bf16 v[48:63], v[92:95], v[80:83], 0
    v_mfma_f32_32x32x16_bf16 v[64:79], v[96:99], v[80:83], 0
    ds_read_b128 v[80:83], v18 offset:0
    ds_read_b64_tr_b16 v[88:89], v24 offset:10752
    ds_read_b64_tr_b16 v[90:91], v24 offset:11088
    ds_read_b64_tr_b16 v[92:93], v24 offset:10808
    ds_read_b64_tr_b16 v[94:95], v24 offset:11144
    ds_read_b64_tr_b16 v[96:97], v24 offset:10864
    ds_read_b64_tr_b16 v[98:99], v24 offset:11200
    s_waitcnt lgkmcnt(7)
    v_mfma_f32_32x32x16_bf16 v[32:47], v[100:103], v[84:87], v[32:47]
    v_mfma_f32_32x32x16_bf16 v[48:63], v[104:107], v[84:87], v[48:63]
    v_mfma_f32_32x32x16_bf16 v[64:79], v[108:111], v[84:87], v[64:79]
    ds_read_b128 v[84:87], v19 offset:0
    ds_read_b64_tr_b16 v[100:101], v24 offset:16128
    ds_read_b64_tr_b16 v[102:103], v24 offset:16464
    ds_read_b64_tr_b16 v[104:105], v24 offset:16184
    ds_read_b64_tr_b16 v[106:107], v24 offset:16520
    ds_read_b64_tr_b16 v[108:109], v24 offset:16240
    ds_read_b64_tr_b16 v[110:111], v24 offset:16576
    s_waitcnt lgkmcnt(7)
    v_mfma_f32_32x32x16_bf16 v[32:47], v[88:91], v[80:83], v[32:47]
    v_mfma_f32_32x32x16_bf16 v[48:63], v[92:95], v[80:83], v[48:63]
    v_mfma_f32_32x32x16_bf16 v[64:79], v[96:99], v[80:83], v[64:79]
    s_waitcnt lgkmcnt(0)
    s_barrier
    ds_read_b128 v[80:83], v16 offset:37888
    ds_read_b64_tr_b16 v[88:89], v24 offset:37888
    ds_read_b64_tr_b16 v[90:91], v24 offset:38224
    ds_read_b64_tr_b16 v[92:93], v24 offset:37944
    ds_read_b64_tr_b16 v[94:95], v24 offset:38280
    ds_read_b64_tr_b16 v[96:97], v24 offset:38000
    ds_read_b64_tr_b16 v[98:99], v24 offset:38336
    v_mfma_f32_32x32x16_bf16 v[32:47], v[100:103], v[84:87], v[32:47]
    v_mfma_f32_32x32x16_bf16 v[48:63], v[104:107], v[84:87], v[48:63]
    v_mfma_f32_32x32x16_bf16 v[64:79], v[108:111], v[84:87], v[64:79]
    ds_read_b128 v[84:87], v17 offset:37888
    ds_read_b64_tr_b16 v[100:101], v24 offset:43264
    ds_read_b64_tr_b16 v[102:103], v24 offset:43600
    ds_read_b64_tr_b16 v[104:105], v24 offset:43320
    ds_read_b64_tr_b16 v[106:107], v24 offset:43656
    ds_read_b64_tr_b16 v[108:109], v24 offset:43376
    ds_read_b64_tr_b16 v[110:111], v24 offset:43712
    s_waitcnt lgkmcnt(7)
    v_mfma_f32_32x32x16_bf16 v[32:47], v[88:91], v[80:83], v[32:47]
    v_mfma_f32_32x32x16_bf16 v[48:63], v[92:95], v[80:83], v[48:63]
    v_mfma_f32_32x32x16_bf16 v[64:79], v[96:99], v[80:83], v[64:79]
    ds_read_b128 v[80:83], v18 offset:37888
    ds_read_b64_tr_b16 v[88:89], v24 offset:48640
    ds_read_b64_tr_b16 v[90:91], v24 offset:48976
    ds_read_b64_tr_b16 v[92:93], v24 offset:48696
    ds_read_b64_tr_b16 v[94:95], v24 offset:49032
    ds_read_b64_tr_b16 v[96:97], v24 offset:48752
    ds_read_b64_tr_b16 v[98:99], v24 offset:49088
    s_waitcnt lgkmcnt(7)
    v_mfma_f32_32x32x16_bf16 v[32:47], v[100:103], v[84:87], v[32:47]
    v_mfma_f32_32x32x16_bf16 v[48:63], v[104:107], v[84:87], v[48:63]
    v_mfma_f32_32x32x16_bf16 v[64:79], v[108:111], v[84:87], v[64:79]
    ds_read_b128 v[84:87], v19 offset:37888
    ds_read_b64_tr_b16 v[100:101], v24 offset:54016
    ds_read_b64_tr_b16 v[102:103], v24 offset:54352
    ds_read_b64_tr_b16 v[104:105], v24 offset:54072
    ds_read_b64_tr_b16 v[106:107], v24 offset:54408
    ds_read_b64_tr_b16 v[108:109], v24 offset:54128
    ds_read_b64_tr_b16 v[110:111], v24 offset:54464
    s_waitcnt lgkmcnt(7)
    v_mfma_f32_32x32x16_bf16 v[32:47], v[88:91], v[80:83], v[32:47]
    v_mfma_f32_32x32x16_bf16 v[48:63], v[92:95], v[80:83], v[48:63]
    v_mfma_f32_32x32x16_bf16 v[64:79], v[96:99], v[80:83], v[64:79]
    s_waitcnt lgkmcnt(0)
    s_barrier
    ds_read_b128 v[80:83], v20 offset:0
    ds_read_b64_tr_b16 v[88:89], v25 offset:0
    ds_read_b64_tr_b16 v[90:91], v25 offset:336
    ds_read_b64_tr_b16 v[92:93], v25 offset:56
    ds_read_b64_tr_b16 v[94:95], v25 offset:392
    ds_read_b64_tr_b16 v[96:97], v25 offset:112
    ds_read_b64_tr_b16 v[98:99], v25 offset:448
    v_mfma_f32_32x32x16_bf16 v[32:47], v[100:103], v[84:87], v[32:47]
    v_mfma_f32_32x32x16_bf16 v[48:63], v[104:107], v[84:87], v[48:63]
    v_mfma_f32_32x32x16_bf16 v[64:79], v[108:111], v[84:87], v[64:79]
    ds_read_b128 v[84:87], v21 offset:0
    ds_read_b64_tr_b16 v[100:101], v25 offset:5376
    ds_read_b64_tr_b16 v[102:103], v25 offset:5712
    ds_read_b64_tr_b16 v[104:105], v25 offset:5432
    ds_read_b64_tr_b16 v[106:107], v25 offset:5768
    ds_read_b64_tr_b16 v[108:109], v25 offset:5488
    ds_read_b64_tr_b16 v[110:111], v25 offset:5824
    s_waitcnt lgkmcnt(7)
    v_mfma_f32_32x32x16_bf16 v[32:47], v[88:91], v[80:83], v[32:47]
    v_mfma_f32_32x32x16_bf16 v[48:63], v[92:95], v[80:83], v[48:63]
    v_mfma_f32_32x32x16_bf16 v[64:79], v[96:99], v[80:83], v[64:79]
    ds_read_b128 v[80:83], v22 offset:0
    ds_read_b64_tr_b16 v[88:89], v25 offset:10752
    ds_read_b64_tr_b16 v[90:91], v25 offset:11088
    ds_read_b64_tr_b16 v[92:93], v25 offset:10808
    ds_read_b64_tr_b16 v[94:95], v25 offset:11144
    ds_read_b64_tr_b16 v[96:97], v25 offset:10864
    ds_read_b64_tr_b16 v[98:99], v25 offset:11200
    s_waitcnt lgkmcnt(7)
    v_mfma_f32_32x32x16_bf16 v[32:47], v[100:103], v[84:87], v[32:47]
    v_mfma_f32_32x32x16_bf16 v[48:63], v[104:107], v[84:87], v[48:63]
    v_mfma_f32_32x32x16_bf16 v[64:79], v[108:111], v[84:87], v[64:79]
    ds_read_b128 v[84:87], v23 offset:0
    ds_read_b64_tr_b16 v[100:101], v25 offset:16128
    ds_read_b64_tr_b16 v[102:103], v25 offset:16464
    ds_read_b64_tr_b16 v[104:105], v25 offset:16184
    ds_read_b64_tr_b16 v[106:107], v25 offset:16520
    ds_read_b64_tr_b16 v[108:109], v25 offset:16240
    ds_read_b64_tr_b16 v[110:111], v25 offset:16576
    s_waitcnt lgkmcnt(7)
    v_mfma_f32_32x32x16_bf16 v[32:47], v[88:91], v[80:83], v[32:47]
    v_mfma_f32_32x32x16_bf16 v[48:63], v[92:95], v[80:83], v[48:63]
    v_mfma_f32_32x32x16_bf16 v[64:79], v[96:99], v[80:83], v[64:79]
    s_waitcnt lgkmcnt(0)
    s_barrier
    ds_read_b128 v[80:83], v20 offset:37888
    ds_read_b64_tr_b16 v[88:89], v25 offset:37888
    ds_read_b64_tr_b16 v[90:91], v25 offset:38224
    ds_read_b64_tr_b16 v[92:93], v25 offset:37944
    ds_read_b64_tr_b16 v[94:95], v25 offset:38280
    ds_read_b64_tr_b16 v[96:97], v25 offset:38000
    ds_read_b64_tr_b16 v[98:99], v25 offset:38336
    v_mfma_f32_32x32x16_bf16 v[32:47], v[100:103], v[84:87], v[32:47]
    v_mfma_f32_32x32x16_bf16 v[48:63], v[104:107], v[84:87], v[48:63]
    v_mfma_f32_32x32x16_bf16 v[64:79], v[108:111], v[84:87], v[64:79]
    ds_read_b128 v[84:87], v21 offset:37888
    ds_read_b64_tr_b16 v[100:101], v25 offset:43264
    ds_read_b64_tr_b16 v[102:103], v25 offset:43600
    ds_read_b64_tr_b16 v[104:105], v25 offset:43320
    ds_read_b64_tr_b16 v[106:107], v25 offset:43656
    ds_read_b64_tr_b16 v[108:109], v25 offset:43376
    ds_read_b64_tr_b16 v[110:111], v25 offset:43712
    s_waitcnt lgkmcnt(7)
    v_mfma_f32_32x32x16_bf16 v[32:47], v[88:91], v[80:83], v[32:47]
    v_mfma_f32_32x32x16_bf16 v[48:63], v[92:95], v[80:83], v[48:63]
    v_mfma_f32_32x32x16_bf16 v[64:79], v[96:99], v[80:83], v[64:79]
    ds_read_b128 v[80:83], v22 offset:37888
    ds_read_b64_tr_b16 v[88:89], v25 offset:48640
    ds_read_b64_tr_b16 v[90:91], v25 offset:48976
    ds_read_b64_tr_b16 v[92:93], v25 offset:48696
    ds_read_b64_tr_b16 v[94:95], v25 offset:49032
    ds_read_b64_tr_b16 v[96:97], v25 offset:48752
    ds_read_b64_tr_b16 v[98:99], v25 offset:49088
    s_waitcnt lgkmcnt(7)
    v_mfma_f32_32x32x16_bf16 v[32:47], v[100:103], v[84:87], v[32:47]
    v_mfma_f32_32x32x16_bf16 v[48:63], v[104:107], v[84:87], v[48:63]
    v_mfma_f32_32x32x16_bf16 v[64:79], v[108:111], v[84:87], v[64:79]
    ds_read_b128 v[84:87], v23 offset:37888
    ds_read_b64_tr_b16 v[100:101], v25 offset:54016
    ds_read_b64_tr_b16 v[102:103], v25 offset:54352
    ds_read_b64_tr_b16 v[104:105], v25 offset:54072
    ds_read_b64_tr_b16 v[106:107], v25 offset:54408
    ds_read_b64_tr_b16 v[108:109], v25 offset:54128
    ds_read_b64_tr_b16 v[110:111], v25 offset:54464
    s_waitcnt lgkmcnt(7)
    v_mfma_f32_32x32x16_bf16 v[32:47], v[88:91], v[80:83], v[32:47]
    v_mfma_f32_32x32x16_bf16 v[48:63], v[92:95], v[80:83], v[48:63]
    v_mfma_f32_32x32x16_bf16 v[64:79], v[96:99], v[80:83], v[64:79]
    s_waitcnt lgkmcnt(0)
    s_barrier
    ds_read_b128 v[112:115], v16 offset:0
    ds_read_b64_tr_b16 v[88:89], v24 offset:0
    ds_read_b64_tr_b16 v[90:91], v24 offset:336
    ds_read_b128 v[116:119], v17 offset:0
    ds_read_b64_tr_b16 v[92:93], v24 offset:5376
    ds_read_b64_tr_b16 v[94:95], v24 offset:5712
    v_mfma_f32_32x32x16_bf16 v[32:47], v[100:103], v[84:87], v[32:47]
    v_mfma_f32_32x32x16_bf16 v[48:63], v[104:107], v[84:87], v[48:63]
    v_mfma_f32_32x32x16_bf16 v[64:79], v[108:111], v[84:87], v[64:79]
    ds_read_b128 v[120:123], v18 offset:0
    ds_read_b64_tr_b16 v[96:97], v24 offset:10752
    ds_read_b64_tr_b16 v[98:99], v24 offset:11088
    s_waitcnt lgkmcnt(6)
    v_mfma_f32_32x32x16_bf16 v[32:47], v[88:91], v[112:115], v[32:47]
    ds_read_b128 v[124:127], v19 offset:0
    ds_read_b64_tr_b16 v[100:101], v24 offset:16128
    ds_read_b64_tr_b16 v[102:103], v24 offset:16464
    s_waitcnt lgkmcnt(6)
    v_mfma_f32_32x32x16_bf16 v[32:47], v[92:95], v[116:119], v[32:47]
    ds_read_b64_tr_b16 v[88:89], v24 offset:56
    ds_read_b64_tr_b16 v[90:91], v24 offset:392
    s_waitcnt lgkmcnt(5)
    v_mfma_f32_32x32x16_bf16 v[32:47], v[96:99], v[120:123], v[32:47]
    ds_read_b64_tr_b16 v[92:93], v24 offset:5432
    ds_read_b64_tr_b16 v[94:95], v24 offset:5768
    s_waitcnt lgkmcnt(4)
    v_mfma_f32_32x32x16_bf16 v[32:47], v[100:103], v[124:127], v[32:47]
    ds_read_b64_tr_b16 v[96:97], v24 offset:10808
    ds_read_b64_tr_b16 v[98:99], v24 offset:11144
    s_waitcnt lgkmcnt(4)
    v_mfma_f32_32x32x16_bf16 v[48:63], v[88:91], v[112:115], v[48:63]
    ds_read_b64_tr_b16 v[100:101], v24 offset:16184
    ds_read_b64_tr_b16 v[102:103], v24 offset:16520
    s_waitcnt lgkmcnt(4)
    v_mfma_f32_32x32x16_bf16 v[48:63], v[92:95], v[116:119], v[48:63]
    s_barrier
    ds_read_b128 v[128:131], v16 offset:37888
    ds_read_b64_tr_b16 v[88:89], v24 offset:37888
    ds_read_b64_tr_b16 v[90:91], v24 offset:38224
    s_waitcnt lgkmcnt(5)
    v_mfma_f32_32x32x16_bf16 v[48:63], v[96:99], v[120:123], v[48:63]
    ds_read_b128 v[132:135], v17 offset:37888
    ds_read_b64_tr_b16 v[92:93], v24 offset:43264
    ds_read_b64_tr_b16 v[94:95], v24 offset:43600
    s_waitcnt lgkmcnt(6)
    v_mfma_f32_32x32x16_bf16 v[48:63], v[100:103], v[124:127], v[48:63]
    ds_read_b128 v[136:139], v18 offset:37888
    ds_read_b64_tr_b16 v[96:97], v24 offset:48640
    ds_read_b64_tr_b16 v[98:99], v24 offset:48976
    s_waitcnt lgkmcnt(6)
    v_mfma_f32_32x32x16_bf16 v[32:47], v[88:91], v[128:131], v[32:47]
    ds_read_b128 v[140:143], v19 offset:37888
    ds_read_b64_tr_b16 v[100:101], v24 offset:54016
    ds_read_b64_tr_b16 v[102:103], v24 offset:54352
    s_waitcnt lgkmcnt(6)
    v_mfma_f32_32x32x16_bf16 v[32:47], v[92:95], v[132:135], v[32:47]
    ds_read_b64_tr_b16 v[88:89], v24 offset:112
    ds_read_b64_tr_b16 v[90:91], v24 offset:448
    s_waitcnt lgkmcnt(5)
    v_mfma_f32_32x32x16_bf16 v[32:47], v[96:99], v[136:139], v[32:47]
    ds_read_b64_tr_b16 v[92:93], v24 offset:5488
    ds_read_b64_tr_b16 v[94:95], v24 offset:5824
    s_waitcnt lgkmcnt(4)
    v_mfma_f32_32x32x16_bf16 v[32:47], v[100:103], v[140:143], v[32:47]
    ds_read_b64_tr_b16 v[96:97], v24 offset:10864
    ds_read_b64_tr_b16 v[98:99], v24 offset:11200
    s_waitcnt lgkmcnt(4)
    v_mfma_f32_32x32x16_bf16 v[64:79], v[88:91], v[112:115], v[64:79]
    ds_read_b64_tr_b16 v[100:101], v24 offset:16240
    ds_read_b64_tr_b16 v[102:103], v24 offset:16576
    s_waitcnt lgkmcnt(4)
    v_mfma_f32_32x32x16_bf16 v[64:79], v[92:95], v[116:119], v[64:79]
    s_barrier
    ds_read_b128 v[144:147], v20 offset:0
    ds_read_b64_tr_b16 v[88:89], v25 offset:0
    ds_read_b64_tr_b16 v[90:91], v25 offset:336
    s_waitcnt lgkmcnt(5)
    v_mfma_f32_32x32x16_bf16 v[64:79], v[96:99], v[120:123], v[64:79]
    ds_read_b128 v[148:151], v21 offset:0
    ds_read_b64_tr_b16 v[92:93], v25 offset:5376
    ds_read_b64_tr_b16 v[94:95], v25 offset:5712
    s_waitcnt lgkmcnt(6)
    v_mfma_f32_32x32x16_bf16 v[64:79], v[100:103], v[124:127], v[64:79]
    ds_read_b128 v[152:155], v22 offset:0
    ds_read_b64_tr_b16 v[96:97], v25 offset:10752
    ds_read_b64_tr_b16 v[98:99], v25 offset:11088
    s_waitcnt lgkmcnt(6)
    v_mfma_f32_32x32x16_bf16 v[32:47], v[88:91], v[144:147], v[32:47]
    ds_read_b128 v[156:159], v23 offset:0
    ds_read_b64_tr_b16 v[100:101], v25 offset:16128
    ds_read_b64_tr_b16 v[102:103], v25 offset:16464
    s_waitcnt lgkmcnt(6)
    v_mfma_f32_32x32x16_bf16 v[32:47], v[92:95], v[148:151], v[32:47]
    ds_read_b64_tr_b16 v[88:89], v24 offset:37944
    ds_read_b64_tr_b16 v[90:91], v24 offset:38280
    s_waitcnt lgkmcnt(5)
    v_mfma_f32_32x32x16_bf16 v[32:47], v[96:99], v[152:155], v[32:47]
    ds_read_b64_tr_b16 v[92:93], v24 offset:43320
    ds_read_b64_tr_b16 v[94:95], v24 offset:43656
    s_waitcnt lgkmcnt(4)
    v_mfma_f32_32x32x16_bf16 v[32:47], v[100:103], v[156:159], v[32:47]
    ds_read_b64_tr_b16 v[96:97], v24 offset:48696
    ds_read_b64_tr_b16 v[98:99], v24 offset:49032
    s_waitcnt lgkmcnt(4)
    v_mfma_f32_32x32x16_bf16 v[48:63], v[88:91], v[128:131], v[48:63]
    ds_read_b64_tr_b16 v[100:101], v24 offset:54072
    ds_read_b64_tr_b16 v[102:103], v24 offset:54408
    s_waitcnt lgkmcnt(4)
    v_mfma_f32_32x32x16_bf16 v[48:63], v[92:95], v[132:135], v[48:63]
    ds_read_b64_tr_b16 v[88:89], v25 offset:56
    ds_read_b64_tr_b16 v[90:91], v25 offset:392
    s_waitcnt lgkmcnt(4)
    v_mfma_f32_32x32x16_bf16 v[48:63], v[96:99], v[136:139], v[48:63]
    v_pk_mul_f32 v[32:33], v[32:33], s[54:55]
    v_pk_mul_f32 v[34:35], v[34:35], s[54:55]
    v_pk_mul_f32 v[36:37], v[36:37], s[54:55]
    v_pk_mul_f32 v[38:39], v[38:39], s[54:55]
    ds_read_b64_tr_b16 v[92:93], v25 offset:5432
    ds_read_b64_tr_b16 v[94:95], v25 offset:5768
    s_waitcnt lgkmcnt(4)
    v_mfma_f32_32x32x16_bf16 v[48:63], v[100:103], v[140:143], v[48:63]
    v_pk_mul_f32 v[40:41], v[40:41], s[54:55]
    v_pk_mul_f32 v[42:43], v[42:43], s[54:55]
    v_pk_mul_f32 v[44:45], v[44:45], s[54:55]
    v_pk_mul_f32 v[46:47], v[46:47], s[54:55]
    ds_read_b64_tr_b16 v[96:97], v25 offset:10808
    ds_read_b64_tr_b16 v[98:99], v25 offset:11144
    s_waitcnt lgkmcnt(4)
    v_mfma_f32_32x32x16_bf16 v[48:63], v[88:91], v[144:147], v[48:63]
    v_cvt_pk_bf16_f32 v160, v32, v33
    v_cvt_pk_bf16_f32 v161, v34, v35
    v_cvt_pk_bf16_f32 v162, v36, v37
    v_cvt_pk_bf16_f32 v163, v38, v39
    ds_read_b64_tr_b16 v[100:101], v25 offset:16184
    ds_read_b64_tr_b16 v[102:103], v25 offset:16520
    s_waitcnt lgkmcnt(4)
    v_mfma_f32_32x32x16_bf16 v[48:63], v[92:95], v[148:151], v[48:63]
    v_cvt_pk_bf16_f32 v164, v40, v41
    v_cvt_pk_bf16_f32 v165, v42, v43
    v_cvt_pk_bf16_f32 v166, v44, v45
    v_cvt_pk_bf16_f32 v167, v46, v47
    ds_read_b64_tr_b16 v[88:89], v24 offset:38000
    ds_read_b64_tr_b16 v[90:91], v24 offset:38336
    s_waitcnt lgkmcnt(4)
    v_mfma_f32_32x32x16_bf16 v[48:63], v[96:99], v[152:155], v[48:63]
    s_mov_b32 exec_lo, 0
    v_mov_b32 v166, s51
    v_mov_b32 v167, 0
    s_mov_b32 exec_lo, -1
    buffer_store_dwordx4 v[160:163], v1, s[16:19], s29 offen sc0 sc1
    buffer_store_dwordx4 v[164:167], v1, s[16:19], s29 offen offset:1024 sc0 sc1
    ds_read_b64_tr_b16 v[92:93], v24 offset:43376
    ds_read_b64_tr_b16 v[94:95], v24 offset:43712
    s_waitcnt lgkmcnt(4)
    v_mfma_f32_32x32x16_bf16 v[48:63], v[100:103], v[156:159], v[48:63]
    ds_read_b64_tr_b16 v[96:97], v24 offset:48752
    ds_read_b64_tr_b16 v[98:99], v24 offset:49088
    s_waitcnt lgkmcnt(4)
    v_mfma_f32_32x32x16_bf16 v[64:79], v[88:91], v[128:131], v[64:79]
    ds_read_b64_tr_b16 v[100:101], v24 offset:54128
    ds_read_b64_tr_b16 v[102:103], v24 offset:54464
    s_waitcnt lgkmcnt(4)
    v_mfma_f32_32x32x16_bf16 v[64:79], v[92:95], v[132:135], v[64:79]
    ds_read_b64_tr_b16 v[88:89], v25 offset:112
    ds_read_b64_tr_b16 v[90:91], v25 offset:448
    s_waitcnt lgkmcnt(4)
    v_mfma_f32_32x32x16_bf16 v[64:79], v[96:99], v[136:139], v[64:79]
    v_pk_mul_f32 v[48:49], v[48:49], s[56:57]
    v_pk_mul_f32 v[50:51], v[50:51], s[56:57]
    v_pk_mul_f32 v[52:53], v[52:53], s[56:57]
    v_pk_mul_f32 v[54:55], v[54:55], s[56:57]
    ds_read_b64_tr_b16 v[92:93], v25 offset:5488
    ds_read_b64_tr_b16 v[94:95], v25 offset:5824
    s_waitcnt lgkmcnt(4)
    v_mfma_f32_32x32x16_bf16 v[64:79], v[100:103], v[140:143], v[64:79]
    v_pk_mul_f32 v[56:57], v[56:57], s[56:57]
    v_pk_mul_f32 v[58:59], v[58:59], s[56:57]
    v_pk_mul_f32 v[60:61], v[60:61], s[56:57]
    v_pk_mul_f32 v[62:63], v[62:63], s[56:57]
    ds_read_b64_tr_b16 v[96:97], v25 offset:10864
    ds_read_b64_tr_b16 v[98:99], v25 offset:11200
    s_waitcnt lgkmcnt(4)
    v_mfma_f32_32x32x16_bf16 v[64:79], v[88:91], v[144:147], v[64:79]
    v_cvt_pk_bf16_f32 v160, v48, v49
    v_cvt_pk_bf16_f32 v161, v50, v51
    v_cvt_pk_bf16_f32 v162, v52, v53
    v_cvt_pk_bf16_f32 v163, v54, v55
    ds_read_b64_tr_b16 v[100:101], v25 offset:16240
    ds_read_b64_tr_b16 v[102:103], v25 offset:16576
    s_waitcnt lgkmcnt(4)
    v_mfma_f32_32x32x16_bf16 v[64:79], v[92:95], v[148:151], v[64:79]
    v_cvt_pk_bf16_f32 v164, v56, v57
    v_cvt_pk_bf16_f32 v165, v58, v59
    v_cvt_pk_bf16_f32 v166, v60, v61
    v_cvt_pk_bf16_f32 v167, v62, v63
    s_waitcnt lgkmcnt(2)
    v_mfma_f32_32x32x16_bf16 v[64:79], v[96:99], v[152:155], v[64:79]
    s_mov_b32 exec_lo, 0
    v_mov_b32 v166, s52
    v_mov_b32 v167, 0
    s_mov_b32 exec_lo, -1
    buffer_store_dwordx4 v[160:163], v1, s[16:19], s30 offen sc0 sc1
    buffer_store_dwordx4 v[164:167], v1, s[16:19], s30 offen offset:1024 sc0 sc1
    s_waitcnt lgkmcnt(0)
    v_mfma_f32_32x32x16_bf16 v[64:79], v[100:103], v[156:159], v[64:79]
    s_nop 7
    s_nop 3
    v_pk_mul_f32 v[64:65], v[64:65], s[58:59]
    v_pk_mul_f32 v[66:67], v[66:67], s[58:59]
    v_pk_mul_f32 v[68:69], v[68:69], s[58:59]
    v_pk_mul_f32 v[70:71], v[70:71], s[58:59]
    v_pk_mul_f32 v[72:73], v[72:73], s[58:59]
    v_pk_mul_f32 v[74:75], v[74:75], s[58:59]
    v_pk_mul_f32 v[76:77], v[76:77], s[58:59]
    v_pk_mul_f32 v[78:79], v[78:79], s[58:59]
    v_cvt_pk_bf16_f32 v160, v64, v65
    v_cvt_pk_bf16_f32 v161, v66, v67
    v_cvt_pk_bf16_f32 v162, v68, v69
    v_cvt_pk_bf16_f32 v163, v70, v71
    v_cvt_pk_bf16_f32 v164, v72, v73
    v_cvt_pk_bf16_f32 v165, v74, v75
    v_cvt_pk_bf16_f32 v166, v76, v77
    v_cvt_pk_bf16_f32 v167, v78, v79
    s_mov_b32 exec_lo, 0
    v_mov_b32 v166, s53
    v_mov_b32 v167, 0
    s_mov_b32 exec_lo, -1
    buffer_store_dwordx4 v[160:163], v1, s[16:19], s31 offen sc0 sc1
    buffer_store_dwordx4 v[164:167], v1, s[16:19], s31 offen offset:1024 sc0 sc1
    s_endpgm
L_k1_m:
    s_barrier
    ds_read_b128 v[80:83], v16 offset:0
    ds_read_b64_tr_b16 v[88:89], v24 offset:0
    ds_read_b64_tr_b16 v[90:91], v24 offset:336
    ds_read_b64_tr_b16 v[92:93], v24 offset:56
    ds_read_b64_tr_b16 v[94:95], v24 offset:392
    ds_read_b64_tr_b16 v[96:97], v24 offset:112
    ds_read_b64_tr_b16 v[98:99], v24 offset:448
    ds_read_b128 v[84:87], v17 offset:0
    ds_read_b64_tr_b16 v[100:101], v24 offset:5376
    ds_read_b64_tr_b16 v[102:103], v24 offset:5712
    ds_read_b64_tr_b16 v[104:105], v24 offset:5432
    ds_read_b64_tr_b16 v[106:107], v24 offset:5768
    ds_read_b64_tr_b16 v[108:109], v24 offset:5488
    ds_read_b64_tr_b16 v[110:111], v24 offset:5824
    s_waitcnt lgkmcnt(7)
    v_mfma_f32_32x32x16_bf16 v[32:47], v[88:91], v[80:83], 0
    v_mfma_f32_32x32x16_bf16 v[48:63], v[92:95], v[80:83], 0
    v_mfma_f32_32x32x16_bf16 v[64:79], v[80:83], v[96:99], 0
    ds_read_b128 v[80:83], v18 offset:0
    ds_read_b64_tr_b16 v[88:89], v24 offset:10752
    ds_read_b64_tr_b16 v[90:91], v24 offset:11088
    ds_read_b64_tr_b16 v[92:93], v24 offset:10808
    ds_read_b64_tr_b16 v[94:95], v24 offset:11144
    ds_read_b64_tr_b16 v[96:97], v24 offset:10864
    ds_read_b64_tr_b16 v[98:99], v24 offset:11200
    s_waitcnt lgkmcnt(7)
    v_mfma_f32_32x32x16_bf16 v[32:47], v[100:103], v[84:87], v[32:47]
    v_mfma_f32_32x32x16_bf16 v[48:63], v[104:107], v[84:87], v[48:63]
    v_mfma_f32_32x32x16_bf16 v[64:79], v[84:87], v[108:111], v[64:79]
    ds_read_b128 v[84:87], v19 offset:0
    ds_read_b64_tr_b16 v[100:101], v24 offset:16128
    ds_read_b64_tr_b16 v[102:103], v24 offset:16464
    ds_read_b64_tr_b16 v[104:105], v24 offset:16184
    ds_read_b64_tr_b16 v[106:107], v24 offset:16520
    ds_read_b64_tr_b16 v[108:109], v24 offset:16240
    ds_read_b64_tr_b16 v[110:111], v24 offset:16576
    s_waitcnt lgkmcnt(7)
    v_mfma_f32_32x32x16_bf16 v[32:47], v[88:91], v[80:83], v[32:47]
    v_mfma_f32_32x32x16_bf16 v[48:63], v[92:95], v[80:83], v[48:63]
    v_mfma_f32_32x32x16_bf16 v[64:79], v[80:83], v[96:99], v[64:79]
    s_waitcnt lgkmcnt(0)
    s_barrier
    ds_read_b128 v[80:83], v16 offset:37888
    ds_read_b64_tr_b16 v[88:89], v24 offset:37888
    ds_read_b64_tr_b16 v[90:91], v24 offset:38224
    ds_read_b64_tr_b16 v[92:93], v24 offset:37944
    ds_read_b64_tr_b16 v[94:95], v24 offset:38280
    ds_read_b64_tr_b16 v[96:97], v24 offset:38000
    ds_read_b64_tr_b16 v[98:99], v24 offset:38336
    v_mfma_f32_32x32x16_bf16 v[32:47], v[100:103], v[84:87], v[32:47]
    v_mfma_f32_32x32x16_bf16 v[48:63], v[104:107], v[84:87], v[48:63]
    v_mfma_f32_32x32x16_bf16 v[64:79], v[84:87], v[108:111], v[64:79]
    ds_read_b128 v[84:87], v17 offset:37888
    ds_read_b64_tr_b16 v[100:101], v24 offset:43264
    ds_read_b64_tr_b16 v[102:103], v24 offset:43600
    ds_read_b64_tr_b16 v[104:105], v24 offset:43320
    ds_read_b64_tr_b16 v[106:107], v24 offset:43656
    ds_read_b64_tr_b16 v[108:109], v24 offset:43376
    ds_read_b64_tr_b16 v[110:111], v24 offset:43712
    s_waitcnt lgkmcnt(7)
    v_mfma_f32_32x32x16_bf16 v[32:47], v[88:91], v[80:83], v[32:47]
    v_mfma_f32_32x32x16_bf16 v[48:63], v[92:95], v[80:83], v[48:63]
    v_mfma_f32_32x32x16_bf16 v[64:79], v[80:83], v[96:99], v[64:79]
    ds_read_b128 v[80:83], v18 offset:37888
    ds_read_b64_tr_b16 v[88:89], v24 offset:48640
    ds_read_b64_tr_b16 v[90:91], v24 offset:48976
    ds_read_b64_tr_b16 v[92:93], v24 offset:48696
    ds_read_b64_tr_b16 v[94:95], v24 offset:49032
    ds_read_b64_tr_b16 v[96:97], v24 offset:48752
    ds_read_b64_tr_b16 v[98:99], v24 offset:49088
    s_waitcnt lgkmcnt(7)
    v_mfma_f32_32x32x16_bf16 v[32:47], v[100:103], v[84:87], v[32:47]
    v_mfma_f32_32x32x16_bf16 v[48:63], v[104:107], v[84:87], v[48:63]
    v_mfma_f32_32x32x16_bf16 v[64:79], v[84:87], v[108:111], v[64:79]
    ds_read_b128 v[84:87], v19 offset:37888
    ds_read_b64_tr_b16 v[100:101], v24 offset:54016
    ds_read_b64_tr_b16 v[102:103], v24 offset:54352
    ds_read_b64_tr_b16 v[104:105], v24 offset:54072
    ds_read_b64_tr_b16 v[106:107], v24 offset:54408
    ds_read_b64_tr_b16 v[108:109], v24 offset:54128
    ds_read_b64_tr_b16 v[110:111], v24 offset:54464
    s_waitcnt lgkmcnt(7)
    v_mfma_f32_32x32x16_bf16 v[32:47], v[88:91], v[80:83], v[32:47]
    v_mfma_f32_32x32x16_bf16 v[48:63], v[92:95], v[80:83], v[48:63]
    v_mfma_f32_32x32x16_bf16 v[64:79], v[80:83], v[96:99], v[64:79]
    s_waitcnt lgkmcnt(0)
    s_barrier
    ds_read_b128 v[80:83], v20 offset:0
    ds_read_b64_tr_b16 v[88:89], v25 offset:0
    ds_read_b64_tr_b16 v[90:91], v25 offset:336
    ds_read_b64_tr_b16 v[92:93], v25 offset:56
    ds_read_b64_tr_b16 v[94:95], v25 offset:392
    ds_read_b64_tr_b16 v[96:97], v25 offset:112
    ds_read_b64_tr_b16 v[98:99], v25 offset:448
    v_mfma_f32_32x32x16_bf16 v[32:47], v[100:103], v[84:87], v[32:47]
    v_mfma_f32_32x32x16_bf16 v[48:63], v[104:107], v[84:87], v[48:63]
    v_mfma_f32_32x32x16_bf16 v[64:79], v[84:87], v[108:111], v[64:79]
    ds_read_b128 v[84:87], v21 offset:0
    ds_read_b64_tr_b16 v[100:101], v25 offset:5376
    ds_read_b64_tr_b16 v[102:103], v25 offset:5712
    ds_read_b64_tr_b16 v[104:105], v25 offset:5432
    ds_read_b64_tr_b16 v[106:107], v25 offset:5768
    ds_read_b64_tr_b16 v[108:109], v25 offset:5488
    ds_read_b64_tr_b16 v[110:111], v25 offset:5824
    s_waitcnt lgkmcnt(7)
    v_mfma_f32_32x32x16_bf16 v[32:47], v[88:91], v[80:83], v[32:47]
    v_mfma_f32_32x32x16_bf16 v[48:63], v[92:95], v[80:83], v[48:63]
    v_mfma_f32_32x32x16_bf16 v[64:79], v[80:83], v[96:99], v[64:79]
    ds_read_b128 v[80:83], v22 offset:0
    ds_read_b64_tr_b16 v[88:89], v25 offset:10752
    ds_read_b64_tr_b16 v[90:91], v25 offset:11088
    ds_read_b64_tr_b16 v[92:93], v25 offset:10808
    ds_read_b64_tr_b16 v[94:95], v25 offset:11144
    ds_read_b64_tr_b16 v[96:97], v25 offset:10864
    ds_read_b64_tr_b16 v[98:99], v25 offset:11200
    s_waitcnt lgkmcnt(7)
    v_mfma_f32_32x32x16_bf16 v[32:47], v[100:103], v[84:87], v[32:47]
    v_mfma_f32_32x32x16_bf16 v[48:63], v[104:107], v[84:87], v[48:63]
    v_mfma_f32_32x32x16_bf16 v[64:79], v[84:87], v[108:111], v[64:79]
    ds_read_b128 v[84:87], v23 offset:0
    ds_read_b64_tr_b16 v[100:101], v25 offset:16128
    ds_read_b64_tr_b16 v[102:103], v25 offset:16464
    ds_read_b64_tr_b16 v[104:105], v25 offset:16184
    ds_read_b64_tr_b16 v[106:107], v25 offset:16520
    ds_read_b64_tr_b16 v[108:109], v25 offset:16240
    ds_read_b64_tr_b16 v[110:111], v25 offset:16576
    s_waitcnt lgkmcnt(7)
    v_mfma_f32_32x32x16_bf16 v[32:47], v[88:91], v[80:83], v[32:47]
    v_mfma_f32_32x32x16_bf16 v[48:63], v[92:95], v[80:83], v[48:63]
    v_mfma_f32_32x32x16_bf16 v[64:79], v[80:83], v[96:99], v[64:79]
    s_waitcnt lgkmcnt(0)
    s_barrier
    ds_read_b128 v[80:83], v20 offset:37888
    ds_read_b64_tr_b16 v[88:89], v25 offset:37888
    ds_read_b64_tr_b16 v[90:91], v25 offset:38224
    ds_read_b64_tr_b16 v[92:93], v25 offset:37944
    ds_read_b64_tr_b16 v[94:95], v25 offset:38280
    ds_read_b64_tr_b16 v[96:97], v25 offset:38000
    ds_read_b64_tr_b16 v[98:99], v25 offset:38336
    v_mfma_f32_32x32x16_bf16 v[32:47], v[100:103], v[84:87], v[32:47]
    v_mfma_f32_32x32x16_bf16 v[48:63], v[104:107], v[84:87], v[48:63]
    v_mfma_f32_32x32x16_bf16 v[64:79], v[84:87], v[108:111], v[64:79]
    ds_read_b128 v[84:87], v21 offset:37888
    ds_read_b64_tr_b16 v[100:101], v25 offset:43264
    ds_read_b64_tr_b16 v[102:103], v25 offset:43600
    ds_read_b64_tr_b16 v[104:105], v25 offset:43320
    ds_read_b64_tr_b16 v[106:107], v25 offset:43656
    ds_read_b64_tr_b16 v[108:109], v25 offset:43376
    ds_read_b64_tr_b16 v[110:111], v25 offset:43712
    s_waitcnt lgkmcnt(7)
    v_mfma_f32_32x32x16_bf16 v[32:47], v[88:91], v[80:83], v[32:47]
    v_mfma_f32_32x32x16_bf16 v[48:63], v[92:95], v[80:83], v[48:63]
    v_mfma_f32_32x32x16_bf16 v[64:79], v[80:83], v[96:99], v[64:79]
    ds_read_b128 v[80:83], v22 offset:37888
    ds_read_b64_tr_b16 v[88:89], v25 offset:48640
    ds_read_b64_tr_b16 v[90:91], v25 offset:48976
    ds_read_b64_tr_b16 v[92:93], v25 offset:48696
    ds_read_b64_tr_b16 v[94:95], v25 offset:49032
    ds_read_b64_tr_b16 v[96:97], v25 offset:48752
    ds_read_b64_tr_b16 v[98:99], v25 offset:49088
    s_waitcnt lgkmcnt(7)
    v_mfma_f32_32x32x16_bf16 v[32:47], v[100:103], v[84:87], v[32:47]
    v_mfma_f32_32x32x16_bf16 v[48:63], v[104:107], v[84:87], v[48:63]
    v_mfma_f32_32x32x16_bf16 v[64:79], v[84:87], v[108:111], v[64:79]
    ds_read_b128 v[84:87], v23 offset:37888
    ds_read_b64_tr_b16 v[100:101], v25 offset:54016
    ds_read_b64_tr_b16 v[102:103], v25 offset:54352
    ds_read_b64_tr_b16 v[104:105], v25 offset:54072
    ds_read_b64_tr_b16 v[106:107], v25 offset:54408
    ds_read_b64_tr_b16 v[108:109], v25 offset:54128
    ds_read_b64_tr_b16 v[110:111], v25 offset:54464
    s_waitcnt lgkmcnt(7)
    v_mfma_f32_32x32x16_bf16 v[32:47], v[88:91], v[80:83], v[32:47]
    v_mfma_f32_32x32x16_bf16 v[48:63], v[92:95], v[80:83], v[48:63]
    v_mfma_f32_32x32x16_bf16 v[64:79], v[80:83], v[96:99], v[64:79]
    s_waitcnt lgkmcnt(0)
    s_barrier
    ds_read_b128 v[112:115], v16 offset:0
    ds_read_b64_tr_b16 v[88:89], v24 offset:0
    ds_read_b64_tr_b16 v[90:91], v24 offset:336
    ds_read_b128 v[116:119], v17 offset:0
    ds_read_b64_tr_b16 v[92:93], v24 offset:5376
    ds_read_b64_tr_b16 v[94:95], v24 offset:5712
    v_mfma_f32_32x32x16_bf16 v[32:47], v[100:103], v[84:87], v[32:47]
    v_mfma_f32_32x32x16_bf16 v[48:63], v[104:107], v[84:87], v[48:63]
    v_mfma_f32_32x32x16_bf16 v[64:79], v[84:87], v[108:111], v[64:79]
    ds_read_b128 v[120:123], v18 offset:0
    ds_read_b64_tr_b16 v[96:97], v24 offset:10752
    ds_read_b64_tr_b16 v[98:99], v24 offset:11088
    s_waitcnt lgkmcnt(6)
    v_mfma_f32_32x32x16_bf16 v[32:47], v[88:91], v[112:115], v[32:47]
    ds_read_b128 v[124:127], v19 offset:0
    ds_read_b64_tr_b16 v[100:101], v24 offset:16128
    ds_read_b64_tr_b16 v[102:103], v24 offset:16464
    s_waitcnt lgkmcnt(6)
    v_mfma_f32_32x32x16_bf16 v[32:47], v[92:95], v[116:119], v[32:47]
    ds_read_b64_tr_b16 v[88:89], v24 offset:56
    ds_read_b64_tr_b16 v[90:91], v24 offset:392
    s_waitcnt lgkmcnt(5)
    v_mfma_f32_32x32x16_bf16 v[32:47], v[96:99], v[120:123], v[32:47]
    ds_read_b64_tr_b16 v[92:93], v24 offset:5432
    ds_read_b64_tr_b16 v[94:95], v24 offset:5768
    s_waitcnt lgkmcnt(4)
    v_mfma_f32_32x32x16_bf16 v[32:47], v[100:103], v[124:127], v[32:47]
    ds_read_b64_tr_b16 v[96:97], v24 offset:10808
    ds_read_b64_tr_b16 v[98:99], v24 offset:11144
    s_waitcnt lgkmcnt(4)
    v_mfma_f32_32x32x16_bf16 v[48:63], v[88:91], v[112:115], v[48:63]
    ds_read_b64_tr_b16 v[100:101], v24 offset:16184
    ds_read_b64_tr_b16 v[102:103], v24 offset:16520
    s_waitcnt lgkmcnt(4)
    v_mfma_f32_32x32x16_bf16 v[48:63], v[92:95], v[116:119], v[48:63]
    s_barrier
    ds_read_b128 v[128:131], v16 offset:37888
    ds_read_b64_tr_b16 v[88:89], v24 offset:37888
    ds_read_b64_tr_b16 v[90:91], v24 offset:38224
    s_waitcnt lgkmcnt(5)
    v_mfma_f32_32x32x16_bf16 v[48:63], v[96:99], v[120:123], v[48:63]
    ds_read_b128 v[132:135], v17 offset:37888
    ds_read_b64_tr_b16 v[92:93], v24 offset:43264
    ds_read_b64_tr_b16 v[94:95], v24 offset:43600
    s_waitcnt lgkmcnt(6)
    v_mfma_f32_32x32x16_bf16 v[48:63], v[100:103], v[124:127], v[48:63]
    ds_read_b128 v[136:139], v18 offset:37888
    ds_read_b64_tr_b16 v[96:97], v24 offset:48640
    ds_read_b64_tr_b16 v[98:99], v24 offset:48976
    s_waitcnt lgkmcnt(6)
    v_mfma_f32_32x32x16_bf16 v[32:47], v[88:91], v[128:131], v[32:47]
    ds_read_b128 v[140:143], v19 offset:37888
    ds_read_b64_tr_b16 v[100:101], v24 offset:54016
    ds_read_b64_tr_b16 v[102:103], v24 offset:54352
    s_waitcnt lgkmcnt(6)
    v_mfma_f32_32x32x16_bf16 v[32:47], v[92:95], v[132:135], v[32:47]
    ds_read_b64_tr_b16 v[88:89], v24 offset:112
    ds_read_b64_tr_b16 v[90:91], v24 offset:448
    s_waitcnt lgkmcnt(5)
    v_mfma_f32_32x32x16_bf16 v[32:47], v[96:99], v[136:139], v[32:47]
    ds_read_b64_tr_b16 v[92:93], v24 offset:5488
    ds_read_b64_tr_b16 v[94:95], v24 offset:5824
    s_waitcnt lgkmcnt(4)
    v_mfma_f32_32x32x16_bf16 v[32:47], v[100:103], v[140:143], v[32:47]
    ds_read_b64_tr_b16 v[96:97], v24 offset:10864
    ds_read_b64_tr_b16 v[98:99], v24 offset:11200
    s_waitcnt lgkmcnt(4)
    v_mfma_f32_32x32x16_bf16 v[64:79], v[112:115], v[88:91], v[64:79]
    ds_read_b64_tr_b16 v[100:101], v24 offset:16240
    ds_read_b64_tr_b16 v[102:103], v24 offset:16576
    s_waitcnt lgkmcnt(4)
    v_mfma_f32_32x32x16_bf16 v[64:79], v[116:119], v[92:95], v[64:79]
    s_barrier
    ds_read_b128 v[144:147], v20 offset:0
    ds_read_b64_tr_b16 v[88:89], v25 offset:0
    ds_read_b64_tr_b16 v[90:91], v25 offset:336
    s_waitcnt lgkmcnt(5)
    v_mfma_f32_32x32x16_bf16 v[64:79], v[120:123], v[96:99], v[64:79]
    ds_read_b128 v[148:151], v21 offset:0
    ds_read_b64_tr_b16 v[92:93], v25 offset:5376
    ds_read_b64_tr_b16 v[94:95], v25 offset:5712
    s_waitcnt lgkmcnt(6)
    v_mfma_f32_32x32x16_bf16 v[64:79], v[124:127], v[100:103], v[64:79]
    ds_read_b128 v[152:155], v22 offset:0
    ds_read_b64_tr_b16 v[96:97], v25 offset:10752
    ds_read_b64_tr_b16 v[98:99], v25 offset:11088
    s_waitcnt lgkmcnt(6)
    v_mfma_f32_32x32x16_bf16 v[32:47], v[88:91], v[144:147], v[32:47]
    ds_read_b128 v[156:159], v23 offset:0
    ds_read_b64_tr_b16 v[100:101], v25 offset:16128
    ds_read_b64_tr_b16 v[102:103], v25 offset:16464
    s_waitcnt lgkmcnt(6)
    v_mfma_f32_32x32x16_bf16 v[32:47], v[92:95], v[148:151], v[32:47]
    ds_read_b64_tr_b16 v[88:89], v24 offset:37944
    ds_read_b64_tr_b16 v[90:91], v24 offset:38280
    s_waitcnt lgkmcnt(5)
    v_mfma_f32_32x32x16_bf16 v[32:47], v[96:99], v[152:155], v[32:47]
    ds_read_b64_tr_b16 v[92:93], v24 offset:43320
    ds_read_b64_tr_b16 v[94:95], v24 offset:43656
    s_waitcnt lgkmcnt(4)
    v_mfma_f32_32x32x16_bf16 v[32:47], v[100:103], v[156:159], v[32:47]
    ds_read_b64_tr_b16 v[96:97], v24 offset:48696
    ds_read_b64_tr_b16 v[98:99], v24 offset:49032
    s_waitcnt lgkmcnt(4)
    v_mfma_f32_32x32x16_bf16 v[48:63], v[88:91], v[128:131], v[48:63]
    ds_read_b64_tr_b16 v[100:101], v24 offset:54072
    ds_read_b64_tr_b16 v[102:103], v24 offset:54408
    s_waitcnt lgkmcnt(4)
    v_mfma_f32_32x32x16_bf16 v[48:63], v[92:95], v[132:135], v[48:63]
    ds_read_b64_tr_b16 v[88:89], v25 offset:56
    ds_read_b64_tr_b16 v[90:91], v25 offset:392
    s_waitcnt lgkmcnt(4)
    v_mfma_f32_32x32x16_bf16 v[48:63], v[96:99], v[136:139], v[48:63]
    v_pk_mul_f32 v[32:33], v[32:33], s[54:55]
    v_pk_mul_f32 v[34:35], v[34:35], s[54:55]
    v_pk_mul_f32 v[36:37], v[36:37], s[54:55]
    v_pk_mul_f32 v[38:39], v[38:39], s[54:55]
    ds_read_b64_tr_b16 v[92:93], v25 offset:5432
    ds_read_b64_tr_b16 v[94:95], v25 offset:5768
    s_waitcnt lgkmcnt(4)
    v_mfma_f32_32x32x16_bf16 v[48:63], v[100:103], v[140:143], v[48:63]
    v_pk_mul_f32 v[40:41], v[40:41], s[54:55]
    v_pk_mul_f32 v[42:43], v[42:43], s[54:55]
    v_pk_mul_f32 v[44:45], v[44:45], s[54:55]
    v_pk_mul_f32 v[46:47], v[46:47], s[54:55]
    ds_read_b64_tr_b16 v[96:97], v25 offset:10808
    ds_read_b64_tr_b16 v[98:99], v25 offset:11144
    s_waitcnt lgkmcnt(4)
    v_mfma_f32_32x32x16_bf16 v[48:63], v[88:91], v[144:147], v[48:63]
    v_cvt_pk_bf16_f32 v160, v32, v33
    v_cvt_pk_bf16_f32 v161, v34, v35
    v_cvt_pk_bf16_f32 v162, v36, v37
    v_cvt_pk_bf16_f32 v163, v38, v39
    ds_read_b64_tr_b16 v[100:101], v25 offset:16184
    ds_read_b64_tr_b16 v[102:103], v25 offset:16520
    s_waitcnt lgkmcnt(4)
    v_mfma_f32_32x32x16_bf16 v[48:63], v[92:95], v[148:151], v[48:63]
    v_cvt_pk_bf16_f32 v164, v40, v41
    v_cvt_pk_bf16_f32 v165, v42, v43
    v_cvt_pk_bf16_f32 v166, v44, v45
    v_cvt_pk_bf16_f32 v167, v46, v47
    ds_read_b64_tr_b16 v[88:89], v24 offset:38000
    ds_read_b64_tr_b16 v[90:91], v24 offset:38336
    s_waitcnt lgkmcnt(4)
    v_mfma_f32_32x32x16_bf16 v[48:63], v[96:99], v[152:155], v[48:63]
    s_mov_b32 exec_lo, 0
    v_mov_b32 v166, s51
    v_mov_b32 v167, 0
    s_mov_b32 exec_lo, -1
    buffer_store_dwordx4 v[160:163], v1, s[16:19], s29 offen sc0 sc1
    buffer_store_dwordx4 v[164:167], v1, s[16:19], s29 offen offset:1024 sc0 sc1
    ds_read_b64_tr_b16 v[92:93], v24 offset:43376
    ds_read_b64_tr_b16 v[94:95], v24 offset:43712
    s_waitcnt lgkmcnt(4)
    v_mfma_f32_32x32x16_bf16 v[48:63], v[100:103], v[156:159], v[48:63]
    ds_read_b64_tr_b16 v[96:97], v24 offset:48752
    ds_read_b64_tr_b16 v[98:99], v24 offset:49088
    s_waitcnt lgkmcnt(4)
    v_mfma_f32_32x32x16_bf16 v[64:79], v[128:131], v[88:91], v[64:79]
    ds_read_b64_tr_b16 v[100:101], v24 offset:54128
    ds_read_b64_tr_b16 v[102:103], v24 offset:54464
    s_waitcnt lgkmcnt(4)
    v_mfma_f32_32x32x16_bf16 v[64:79], v[132:135], v[92:95], v[64:79]
    ds_read_b64_tr_b16 v[88:89], v25 offset:112
    ds_read_b64_tr_b16 v[90:91], v25 offset:448
    s_waitcnt lgkmcnt(4)
    v_mfma_f32_32x32x16_bf16 v[64:79], v[136:139], v[96:99], v[64:79]
    v_pk_mul_f32 v[48:49], v[48:49], s[56:57]
    v_pk_mul_f32 v[50:51], v[50:51], s[56:57]
    v_pk_mul_f32 v[52:53], v[52:53], s[56:57]
    v_pk_mul_f32 v[54:55], v[54:55], s[56:57]
    ds_read_b64_tr_b16 v[92:93], v25 offset:5488
    ds_read_b64_tr_b16 v[94:95], v25 offset:5824
    s_waitcnt lgkmcnt(4)
    v_mfma_f32_32x32x16_bf16 v[64:79], v[140:143], v[100:103], v[64:79]
    v_pk_mul_f32 v[56:57], v[56:57], s[56:57]
    v_pk_mul_f32 v[58:59], v[58:59], s[56:57]
    v_pk_mul_f32 v[60:61], v[60:61], s[56:57]
    v_pk_mul_f32 v[62:63], v[62:63], s[56:57]
    ds_read_b64_tr_b16 v[96:97], v25 offset:10864
    ds_read_b64_tr_b16 v[98:99], v25 offset:11200
    s_waitcnt lgkmcnt(4)
    v_mfma_f32_32x32x16_bf16 v[64:79], v[144:147], v[88:91], v[64:79]
    v_cvt_pk_bf16_f32 v160, v48, v49
    v_cvt_pk_bf16_f32 v161, v50, v51
    v_cvt_pk_bf16_f32 v162, v52, v53
    v_cvt_pk_bf16_f32 v163, v54, v55
    ds_read_b64_tr_b16 v[100:101], v25 offset:16240
    ds_read_b64_tr_b16 v[102:103], v25 offset:16576
    s_waitcnt lgkmcnt(4)
    v_mfma_f32_32x32x16_bf16 v[64:79], v[148:151], v[92:95], v[64:79]
    v_cvt_pk_bf16_f32 v164, v56, v57
    v_cvt_pk_bf16_f32 v165, v58, v59
    v_cvt_pk_bf16_f32 v166, v60, v61
    v_cvt_pk_bf16_f32 v167, v62, v63
    s_waitcnt lgkmcnt(2)
    v_mfma_f32_32x32x16_bf16 v[64:79], v[152:155], v[96:99], v[64:79]
    s_mov_b32 exec_lo, 0
    v_mov_b32 v166, s52
    v_mov_b32 v167, 0
    s_mov_b32 exec_lo, -1
    buffer_store_dwordx4 v[160:163], v1, s[16:19], s30 offen sc0 sc1
    buffer_store_dwordx4 v[164:167], v1, s[16:19], s30 offen offset:1024 sc0 sc1
    s_waitcnt lgkmcnt(0)
    v_mfma_f32_32x32x16_bf16 v[64:79], v[156:159], v[100:103], v[64:79]
    s_nop 7
    s_nop 3
    v_cvt_pk_bf16_f32 v160, v64, v65
    v_cvt_pk_bf16_f32 v161, v66, v67
    v_cvt_pk_bf16_f32 v162, v68, v69
    v_cvt_pk_bf16_f32 v163, v70, v71
    v_cvt_pk_bf16_f32 v164, v72, v73
    v_cvt_pk_bf16_f32 v165, v74, v75
    v_cvt_pk_bf16_f32 v166, v76, v77
    v_cvt_pk_bf16_f32 v167, v78, v79
    s_mov_b32 exec_lo, 0xf0000000
    s_mov_b32 exec_hi, 0xf0000000
    v_mov_b32 v160, v26
    v_mov_b32 v161, v26
    v_mov_b32 v162, v26
    v_mov_b32 v163, v26
    v_mov_b32 v164, v26
    v_mov_b32 v165, v26
    v_mov_b32 v166, v26
    v_mov_b32 v167, v26
    s_mov_b64 exec, -1
    buffer_store_dwordx4 v[160:163], v1, s[16:19], s31 offen sc0 sc1
    buffer_store_dwordx4 v[164:167], v1, s[16:19], s31 offen offset:1024 sc0 sc1
    s_endpgm
L_k1_v:
    s_barrier
    ds_read_b128 v[80:83], v16 offset:0
    ds_read_b64_tr_b16 v[88:89], v24 offset:0
    ds_read_b64_tr_b16 v[90:91], v24 offset:336
    ds_read_b64_tr_b16 v[92:93], v24 offset:56
    ds_read_b64_tr_b16 v[94:95], v24 offset:392
    ds_read_b64_tr_b16 v[96:97], v24 offset:112
    ds_read_b64_tr_b16 v[98:99], v24 offset:448
    ds_read_b128 v[84:87], v17 offset:0
    ds_read_b64_tr_b16 v[100:101], v24 offset:5376
    ds_read_b64_tr_b16 v[102:103], v24 offset:5712
    ds_read_b64_tr_b16 v[104:105], v24 offset:5432
    ds_read_b64_tr_b16 v[106:107], v24 offset:5768
    ds_read_b64_tr_b16 v[108:109], v24 offset:5488
    ds_read_b64_tr_b16 v[110:111], v24 offset:5824
    s_waitcnt lgkmcnt(7)
    v_mfma_f32_32x32x16_bf16 v[32:47], v[80:83], v[88:91], 0
    v_mfma_f32_32x32x16_bf16 v[48:63], v[80:83], v[92:95], 0
    v_mfma_f32_32x32x16_bf16 v[64:79], v[80:83], v[96:99], 0
    ds_read_b128 v[80:83], v18 offset:0
    ds_read_b64_tr_b16 v[88:89], v24 offset:10752
    ds_read_b64_tr_b16 v[90:91], v24 offset:11088
    ds_read_b64_tr_b16 v[92:93], v24 offset:10808
    ds_read_b64_tr_b16 v[94:95], v24 offset:11144
    ds_read_b64_tr_b16 v[96:97], v24 offset:10864
    ds_read_b64_tr_b16 v[98:99], v24 offset:11200
    s_waitcnt lgkmcnt(7)
    v_mfma_f32_32x32x16_bf16 v[32:47], v[84:87], v[100:103], v[32:47]
    v_mfma_f32_32x32x16_bf16 v[48:63], v[84:87], v[104:107], v[48:63]
    v_mfma_f32_32x32x16_bf16 v[64:79], v[84:87], v[108:111], v[64:79]
    ds_read_b128 v[84:87], v19 offset:0
    ds_read_b64_tr_b16 v[100:101], v24 offset:16128
    ds_read_b64_tr_b16 v[102:103], v24 offset:16464
    ds_read_b64_tr_b16 v[104:105], v24 offset:16184
    ds_read_b64_tr_b16 v[106:107], v24 offset:16520
    ds_read_b64_tr_b16 v[108:109], v24 offset:16240
    ds_read_b64_tr_b16 v[110:111], v24 offset:16576
    s_waitcnt lgkmcnt(7)
    v_mfma_f32_32x32x16_bf16 v[32:47], v[80:83], v[88:91], v[32:47]
    v_mfma_f32_32x32x16_bf16 v[48:63], v[80:83], v[92:95], v[48:63]
    v_mfma_f32_32x32x16_bf16 v[64:79], v[80:83], v[96:99], v[64:79]
    s_waitcnt lgkmcnt(0)
    s_barrier
    ds_read_b128 v[80:83], v16 offset:37888
    ds_read_b64_tr_b16 v[88:89], v24 offset:37888
    ds_read_b64_tr_b16 v[90:91], v24 offset:38224
    ds_read_b64_tr_b16 v[92:93], v24 offset:37944
    ds_read_b64_tr_b16 v[94:95], v24 offset:38280
    ds_read_b64_tr_b16 v[96:97], v24 offset:38000
    ds_read_b64_tr_b16 v[98:99], v24 offset:38336
    v_mfma_f32_32x32x16_bf16 v[32:47], v[84:87], v[100:103], v[32:47]
    v_mfma_f32_32x32x16_bf16 v[48:63], v[84:87], v[104:107], v[48:63]
    v_mfma_f32_32x32x16_bf16 v[64:79], v[84:87], v[108:111], v[64:79]
    ds_read_b128 v[84:87], v17 offset:37888
    ds_read_b64_tr_b16 v[100:101], v24 offset:43264
    ds_read_b64_tr_b16 v[102:103], v24 offset:43600
    ds_read_b64_tr_b16 v[104:105], v24 offset:43320
    ds_read_b64_tr_b16 v[106:107], v24 offset:43656
    ds_read_b64_tr_b16 v[108:109], v24 offset:43376
    ds_read_b64_tr_b16 v[110:111], v24 offset:43712
    s_waitcnt lgkmcnt(7)
    v_mfma_f32_32x32x16_bf16 v[32:47], v[80:83], v[88:91], v[32:47]
    v_mfma_f32_32x32x16_bf16 v[48:63], v[80:83], v[92:95], v[48:63]
    v_mfma_f32_32x32x16_bf16 v[64:79], v[80:83], v[96:99], v[64:79]
    ds_read_b128 v[80:83], v18 offset:37888
    ds_read_b64_tr_b16 v[88:89], v24 offset:48640
    ds_read_b64_tr_b16 v[90:91], v24 offset:48976
    ds_read_b64_tr_b16 v[92:93], v24 offset:48696
    ds_read_b64_tr_b16 v[94:95], v24 offset:49032
    ds_read_b64_tr_b16 v[96:97], v24 offset:48752
    ds_read_b64_tr_b16 v[98:99], v24 offset:49088
    s_waitcnt lgkmcnt(7)
    v_mfma_f32_32x32x16_bf16 v[32:47], v[84:87], v[100:103], v[32:47]
    v_mfma_f32_32x32x16_bf16 v[48:63], v[84:87], v[104:107], v[48:63]
    v_mfma_f32_32x32x16_bf16 v[64:79], v[84:87], v[108:111], v[64:79]
    ds_read_b128 v[84:87], v19 offset:37888
    ds_read_b64_tr_b16 v[100:101], v24 offset:54016
    ds_read_b64_tr_b16 v[102:103], v24 offset:54352
    ds_read_b64_tr_b16 v[104:105], v24 offset:54072
    ds_read_b64_tr_b16 v[106:107], v24 offset:54408
    ds_read_b64_tr_b16 v[108:109], v24 offset:54128
    ds_read_b64_tr_b16 v[110:111], v24 offset:54464
    s_waitcnt lgkmcnt(7)
    v_mfma_f32_32x32x16_bf16 v[32:47], v[80:83], v[88:91], v[32:47]
    v_mfma_f32_32x32x16_bf16 v[48:63], v[80:83], v[92:95], v[48:63]
    v_mfma_f32_32x32x16_bf16 v[64:79], v[80:83], v[96:99], v[64:79]
    s_waitcnt lgkmcnt(0)
    s_barrier
    ds_read_b128 v[80:83], v20 offset:0
    ds_read_b64_tr_b16 v[88:89], v25 offset:0
    ds_read_b64_tr_b16 v[90:91], v25 offset:336
    ds_read_b64_tr_b16 v[92:93], v25 offset:56
    ds_read_b64_tr_b16 v[94:95], v25 offset:392
    ds_read_b64_tr_b16 v[96:97], v25 offset:112
    ds_read_b64_tr_b16 v[98:99], v25 offset:448
    v_mfma_f32_32x32x16_bf16 v[32:47], v[84:87], v[100:103], v[32:47]
    v_mfma_f32_32x32x16_bf16 v[48:63], v[84:87], v[104:107], v[48:63]
    v_mfma_f32_32x32x16_bf16 v[64:79], v[84:87], v[108:111], v[64:79]
    ds_read_b128 v[84:87], v21 offset:0
    ds_read_b64_tr_b16 v[100:101], v25 offset:5376
    ds_read_b64_tr_b16 v[102:103], v25 offset:5712
    ds_read_b64_tr_b16 v[104:105], v25 offset:5432
    ds_read_b64_tr_b16 v[106:107], v25 offset:5768
    ds_read_b64_tr_b16 v[108:109], v25 offset:5488
    ds_read_b64_tr_b16 v[110:111], v25 offset:5824
    s_waitcnt lgkmcnt(7)
    v_mfma_f32_32x32x16_bf16 v[32:47], v[80:83], v[88:91], v[32:47]
    v_mfma_f32_32x32x16_bf16 v[48:63], v[80:83], v[92:95], v[48:63]
    v_mfma_f32_32x32x16_bf16 v[64:79], v[80:83], v[96:99], v[64:79]
    ds_read_b128 v[80:83], v22 offset:0
    ds_read_b64_tr_b16 v[88:89], v25 offset:10752
    ds_read_b64_tr_b16 v[90:91], v25 offset:11088
    ds_read_b64_tr_b16 v[92:93], v25 offset:10808
    ds_read_b64_tr_b16 v[94:95], v25 offset:11144
    ds_read_b64_tr_b16 v[96:97], v25 offset:10864
    ds_read_b64_tr_b16 v[98:99], v25 offset:11200
    s_waitcnt lgkmcnt(7)
    v_mfma_f32_32x32x16_bf16 v[32:47], v[84:87], v[100:103], v[32:47]
    v_mfma_f32_32x32x16_bf16 v[48:63], v[84:87], v[104:107], v[48:63]
    v_mfma_f32_32x32x16_bf16 v[64:79], v[84:87], v[108:111], v[64:79]
    ds_read_b128 v[84:87], v23 offset:0
    ds_read_b64_tr_b16 v[100:101], v25 offset:16128
    ds_read_b64_tr_b16 v[102:103], v25 offset:16464
    ds_read_b64_tr_b16 v[104:105], v25 offset:16184
    ds_read_b64_tr_b16 v[106:107], v25 offset:16520
    ds_read_b64_tr_b16 v[108:109], v25 offset:16240
    ds_read_b64_tr_b16 v[110:111], v25 offset:16576
    s_waitcnt lgkmcnt(7)
    v_mfma_f32_32x32x16_bf16 v[32:47], v[80:83], v[88:91], v[32:47]
    v_mfma_f32_32x32x16_bf16 v[48:63], v[80:83], v[92:95], v[48:63]
    v_mfma_f32_32x32x16_bf16 v[64:79], v[80:83], v[96:99], v[64:79]
    s_waitcnt lgkmcnt(0)
    s_barrier
    ds_read_b128 v[80:83], v20 offset:37888
    ds_read_b64_tr_b16 v[88:89], v25 offset:37888
    ds_read_b64_tr_b16 v[90:91], v25 offset:38224
    ds_read_b64_tr_b16 v[92:93], v25 offset:37944
    ds_read_b64_tr_b16 v[94:95], v25 offset:38280
    ds_read_b64_tr_b16 v[96:97], v25 offset:38000
    ds_read_b64_tr_b16 v[98:99], v25 offset:38336
    v_mfma_f32_32x32x16_bf16 v[32:47], v[84:87], v[100:103], v[32:47]
    v_mfma_f32_32x32x16_bf16 v[48:63], v[84:87], v[104:107], v[48:63]
    v_mfma_f32_32x32x16_bf16 v[64:79], v[84:87], v[108:111], v[64:79]
    ds_read_b128 v[84:87], v21 offset:37888
    ds_read_b64_tr_b16 v[100:101], v25 offset:43264
    ds_read_b64_tr_b16 v[102:103], v25 offset:43600
    ds_read_b64_tr_b16 v[104:105], v25 offset:43320
    ds_read_b64_tr_b16 v[106:107], v25 offset:43656
    ds_read_b64_tr_b16 v[108:109], v25 offset:43376
    ds_read_b64_tr_b16 v[110:111], v25 offset:43712
    s_waitcnt lgkmcnt(7)
    v_mfma_f32_32x32x16_bf16 v[32:47], v[80:83], v[88:91], v[32:47]
    v_mfma_f32_32x32x16_bf16 v[48:63], v[80:83], v[92:95], v[48:63]
    v_mfma_f32_32x32x16_bf16 v[64:79], v[80:83], v[96:99], v[64:79]
    ds_read_b128 v[80:83], v22 offset:37888
    ds_read_b64_tr_b16 v[88:89], v25 offset:48640
    ds_read_b64_tr_b16 v[90:91], v25 offset:48976
    ds_read_b64_tr_b16 v[92:93], v25 offset:48696
    ds_read_b64_tr_b16 v[94:95], v25 offset:49032
    ds_read_b64_tr_b16 v[96:97], v25 offset:48752
    ds_read_b64_tr_b16 v[98:99], v25 offset:49088
    s_waitcnt lgkmcnt(7)
    v_mfma_f32_32x32x16_bf16 v[32:47], v[84:87], v[100:103], v[32:47]
    v_mfma_f32_32x32x16_bf16 v[48:63], v[84:87], v[104:107], v[48:63]
    v_mfma_f32_32x32x16_bf16 v[64:79], v[84:87], v[108:111], v[64:79]
    ds_read_b128 v[84:87], v23 offset:37888
    ds_read_b64_tr_b16 v[100:101], v25 offset:54016
    ds_read_b64_tr_b16 v[102:103], v25 offset:54352
    ds_read_b64_tr_b16 v[104:105], v25 offset:54072
    ds_read_b64_tr_b16 v[106:107], v25 offset:54408
    ds_read_b64_tr_b16 v[108:109], v25 offset:54128
    ds_read_b64_tr_b16 v[110:111], v25 offset:54464
    s_waitcnt lgkmcnt(7)
    v_mfma_f32_32x32x16_bf16 v[32:47], v[80:83], v[88:91], v[32:47]
    v_mfma_f32_32x32x16_bf16 v[48:63], v[80:83], v[92:95], v[48:63]
    v_mfma_f32_32x32x16_bf16 v[64:79], v[80:83], v[96:99], v[64:79]
    s_waitcnt lgkmcnt(0)
    s_barrier
    ds_read_b128 v[112:115], v16 offset:0
    ds_read_b64_tr_b16 v[88:89], v24 offset:0
    ds_read_b64_tr_b16 v[90:91], v24 offset:336
    ds_read_b128 v[116:119], v17 offset:0
    ds_read_b64_tr_b16 v[92:93], v24 offset:5376
    ds_read_b64_tr_b16 v[94:95], v24 offset:5712
    v_mfma_f32_32x32x16_bf16 v[32:47], v[84:87], v[100:103], v[32:47]
    v_mfma_f32_32x32x16_bf16 v[48:63], v[84:87], v[104:107], v[48:63]
    v_mfma_f32_32x32x16_bf16 v[64:79], v[84:87], v[108:111], v[64:79]
    ds_read_b128 v[120:123], v18 offset:0
    ds_read_b64_tr_b16 v[96:97], v24 offset:10752
    ds_read_b64_tr_b16 v[98:99], v24 offset:11088
    s_waitcnt lgkmcnt(6)
    v_mfma_f32_32x32x16_bf16 v[32:47], v[112:115], v[88:91], v[32:47]
    ds_read_b128 v[124:127], v19 offset:0
    ds_read_b64_tr_b16 v[100:101], v24 offset:16128
    ds_read_b64_tr_b16 v[102:103], v24 offset:16464
    s_waitcnt lgkmcnt(6)
    v_mfma_f32_32x32x16_bf16 v[32:47], v[116:119], v[92:95], v[32:47]
    ds_read_b64_tr_b16 v[88:89], v24 offset:56
    ds_read_b64_tr_b16 v[90:91], v24 offset:392
    s_waitcnt lgkmcnt(5)
    v_mfma_f32_32x32x16_bf16 v[32:47], v[120:123], v[96:99], v[32:47]
    ds_read_b64_tr_b16 v[92:93], v24 offset:5432
    ds_read_b64_tr_b16 v[94:95], v24 offset:5768
    s_waitcnt lgkmcnt(4)
    v_mfma_f32_32x32x16_bf16 v[32:47], v[124:127], v[100:103], v[32:47]
    ds_read_b64_tr_b16 v[96:97], v24 offset:10808
    ds_read_b64_tr_b16 v[98:99], v24 offset:11144
    s_waitcnt lgkmcnt(4)
    v_mfma_f32_32x32x16_bf16 v[48:63], v[112:115], v[88:91], v[48:63]
    ds_read_b64_tr_b16 v[100:101], v24 offset:16184
    ds_read_b64_tr_b16 v[102:103], v24 offset:16520
    s_waitcnt lgkmcnt(4)
    v_mfma_f32_32x32x16_bf16 v[48:63], v[116:119], v[92:95], v[48:63]
    s_barrier
    ds_read_b128 v[128:131], v16 offset:37888
    ds_read_b64_tr_b16 v[88:89], v24 offset:37888
    ds_read_b64_tr_b16 v[90:91], v24 offset:38224
    s_waitcnt lgkmcnt(5)
    v_mfma_f32_32x32x16_bf16 v[48:63], v[120:123], v[96:99], v[48:63]
    ds_read_b128 v[132:135], v17 offset:37888
    ds_read_b64_tr_b16 v[92:93], v24 offset:43264
    ds_read_b64_tr_b16 v[94:95], v24 offset:43600
    s_waitcnt lgkmcnt(6)
    v_mfma_f32_32x32x16_bf16 v[48:63], v[124:127], v[100:103], v[48:63]
    ds_read_b128 v[136:139], v18 offset:37888
    ds_read_b64_tr_b16 v[96:97], v24 offset:48640
    ds_read_b64_tr_b16 v[98:99], v24 offset:48976
    s_waitcnt lgkmcnt(6)
    v_mfma_f32_32x32x16_bf16 v[32:47], v[128:131], v[88:91], v[32:47]
    ds_read_b128 v[140:143], v19 offset:37888
    ds_read_b64_tr_b16 v[100:101], v24 offset:54016
    ds_read_b64_tr_b16 v[102:103], v24 offset:54352
    s_waitcnt lgkmcnt(6)
    v_mfma_f32_32x32x16_bf16 v[32:47], v[132:135], v[92:95], v[32:47]
    ds_read_b64_tr_b16 v[88:89], v24 offset:112
    ds_read_b64_tr_b16 v[90:91], v24 offset:448
    s_waitcnt lgkmcnt(5)
    v_mfma_f32_32x32x16_bf16 v[32:47], v[136:139], v[96:99], v[32:47]
    ds_read_b64_tr_b16 v[92:93], v24 offset:5488
    ds_read_b64_tr_b16 v[94:95], v24 offset:5824
    s_waitcnt lgkmcnt(4)
    v_mfma_f32_32x32x16_bf16 v[32:47], v[140:143], v[100:103], v[32:47]
    ds_read_b64_tr_b16 v[96:97], v24 offset:10864
    ds_read_b64_tr_b16 v[98:99], v24 offset:11200
    s_waitcnt lgkmcnt(4)
    v_mfma_f32_32x32x16_bf16 v[64:79], v[112:115], v[88:91], v[64:79]
    ds_read_b64_tr_b16 v[100:101], v24 offset:16240
    ds_read_b64_tr_b16 v[102:103], v24 offset:16576
    s_waitcnt lgkmcnt(4)
    v_mfma_f32_32x32x16_bf16 v[64:79], v[116:119], v[92:95], v[64:79]
    s_barrier
    ds_read_b128 v[144:147], v20 offset:0
    ds_read_b64_tr_b16 v[88:89], v25 offset:0
    ds_read_b64_tr_b16 v[90:91], v25 offset:336
    s_waitcnt lgkmcnt(5)
    v_mfma_f32_32x32x16_bf16 v[64:79], v[120:123], v[96:99], v[64:79]
    ds_read_b128 v[148:151], v21 offset:0
    ds_read_b64_tr_b16 v[92:93], v25 offset:5376
    ds_read_b64_tr_b16 v[94:95], v25 offset:5712
    s_waitcnt lgkmcnt(6)
    v_mfma_f32_32x32x16_bf16 v[64:79], v[124:127], v[100:103], v[64:79]
    ds_read_b128 v[152:155], v22 offset:0
    ds_read_b64_tr_b16 v[96:97], v25 offset:10752
    ds_read_b64_tr_b16 v[98:99], v25 offset:11088
    s_waitcnt lgkmcnt(6)
    v_mfma_f32_32x32x16_bf16 v[32:47], v[144:147], v[88:91], v[32:47]
    ds_read_b128 v[156:159], v23 offset:0
    ds_read_b64_tr_b16 v[100:101], v25 offset:16128
    ds_read_b64_tr_b16 v[102:103], v25 offset:16464
    s_waitcnt lgkmcnt(6)
    v_mfma_f32_32x32x16_bf16 v[32:47], v[148:151], v[92:95], v[32:47]
    ds_read_b64_tr_b16 v[88:89], v24 offset:37944
    ds_read_b64_tr_b16 v[90:91], v24 offset:38280
    s_waitcnt lgkmcnt(5)
    v_mfma_f32_32x32x16_bf16 v[32:47], v[152:155], v[96:99], v[32:47]
    ds_read_b64_tr_b16 v[92:93], v24 offset:43320
    ds_read_b64_tr_b16 v[94:95], v24 offset:43656
    s_waitcnt lgkmcnt(4)
    v_mfma_f32_32x32x16_bf16 v[32:47], v[156:159], v[100:103], v[32:47]
    ds_read_b64_tr_b16 v[96:97], v24 offset:48696
    ds_read_b64_tr_b16 v[98:99], v24 offset:49032
    s_waitcnt lgkmcnt(4)
    v_mfma_f32_32x32x16_bf16 v[48:63], v[128:131], v[88:91], v[48:63]
    ds_read_b64_tr_b16 v[100:101], v24 offset:54072
    ds_read_b64_tr_b16 v[102:103], v24 offset:54408
    s_waitcnt lgkmcnt(4)
    v_mfma_f32_32x32x16_bf16 v[48:63], v[132:135], v[92:95], v[48:63]
    ds_read_b64_tr_b16 v[88:89], v25 offset:56
    ds_read_b64_tr_b16 v[90:91], v25 offset:392
    s_waitcnt lgkmcnt(4)
    v_mfma_f32_32x32x16_bf16 v[48:63], v[136:139], v[96:99], v[48:63]
    v_cvt_pk_bf16_f32 v160, v32, v33
    v_cvt_pk_bf16_f32 v161, v34, v35
    v_cvt_pk_bf16_f32 v162, v36, v37
    v_cvt_pk_bf16_f32 v163, v38, v39
    ds_read_b64_tr_b16 v[92:93], v25 offset:5432
    ds_read_b64_tr_b16 v[94:95], v25 offset:5768
    s_waitcnt lgkmcnt(4)
    v_mfma_f32_32x32x16_bf16 v[48:63], v[140:143], v[100:103], v[48:63]
    v_cvt_pk_bf16_f32 v164, v40, v41
    v_cvt_pk_bf16_f32 v165, v42, v43
    v_cvt_pk_bf16_f32 v166, v44, v45
    v_cvt_pk_bf16_f32 v167, v46, v47
    ds_read_b64_tr_b16 v[96:97], v25 offset:10808
    ds_read_b64_tr_b16 v[98:99], v25 offset:11144
    s_waitcnt lgkmcnt(4)
    v_mfma_f32_32x32x16_bf16 v[48:63], v[144:147], v[88:91], v[48:63]
    s_mov_b32 exec_lo, 0xf0000000
    s_mov_b32 exec_hi, 0xf0000000
    v_mov_b32 v160, v26
    v_mov_b32 v161, v26
    v_mov_b32 v162, v26
    v_mov_b32 v163, v26
    v_mov_b32 v164, v26
    v_mov_b32 v165, v26
    v_mov_b32 v166, v26
    v_mov_b32 v167, v26
    s_mov_b64 exec, -1
    buffer_store_dwordx4 v[160:163], v1, s[16:19], s29 offen sc0 sc1
    buffer_store_dwordx4 v[164:167], v1, s[16:19], s29 offen offset:1024 sc0 sc1
    ds_read_b64_tr_b16 v[100:101], v25 offset:16184
    ds_read_b64_tr_b16 v[102:103], v25 offset:16520
    s_waitcnt lgkmcnt(4)
    v_mfma_f32_32x32x16_bf16 v[48:63], v[148:151], v[92:95], v[48:63]
    ds_read_b64_tr_b16 v[88:89], v24 offset:38000
    ds_read_b64_tr_b16 v[90:91], v24 offset:38336
    s_waitcnt lgkmcnt(4)
    v_mfma_f32_32x32x16_bf16 v[48:63], v[152:155], v[96:99], v[48:63]
    ds_read_b64_tr_b16 v[92:93], v24 offset:43376
    ds_read_b64_tr_b16 v[94:95], v24 offset:43712
    s_waitcnt lgkmcnt(4)
    v_mfma_f32_32x32x16_bf16 v[48:63], v[156:159], v[100:103], v[48:63]
    ds_read_b64_tr_b16 v[96:97], v24 offset:48752
    ds_read_b64_tr_b16 v[98:99], v24 offset:49088
    s_waitcnt lgkmcnt(4)
    v_mfma_f32_32x32x16_bf16 v[64:79], v[128:131], v[88:91], v[64:79]
    ds_read_b64_tr_b16 v[100:101], v24 offset:54128
    ds_read_b64_tr_b16 v[102:103], v24 offset:54464
    s_waitcnt lgkmcnt(4)
    v_mfma_f32_32x32x16_bf16 v[64:79], v[132:135], v[92:95], v[64:79]
    ds_read_b64_tr_b16 v[88:89], v25 offset:112
    ds_read_b64_tr_b16 v[90:91], v25 offset:448
    s_waitcnt lgkmcnt(4)
    v_mfma_f32_32x32x16_bf16 v[64:79], v[136:139], v[96:99], v[64:79]
    v_cvt_pk_bf16_f32 v160, v48, v49
    v_cvt_pk_bf16_f32 v161, v50, v51
    v_cvt_pk_bf16_f32 v162, v52, v53
    v_cvt_pk_bf16_f32 v163, v54, v55
    ds_read_b64_tr_b16 v[92:93], v25 offset:5488
    ds_read_b64_tr_b16 v[94:95], v25 offset:5824
    s_waitcnt lgkmcnt(4)
    v_mfma_f32_32x32x16_bf16 v[64:79], v[140:143], v[100:103], v[64:79]
    v_cvt_pk_bf16_f32 v164, v56, v57
    v_cvt_pk_bf16_f32 v165, v58, v59
    v_cvt_pk_bf16_f32 v166, v60, v61
    v_cvt_pk_bf16_f32 v167, v62, v63
    ds_read_b64_tr_b16 v[96:97], v25 offset:10864
    ds_read_b64_tr_b16 v[98:99], v25 offset:11200
    s_waitcnt lgkmcnt(4)
    v_mfma_f32_32x32x16_bf16 v[64:79], v[144:147], v[88:91], v[64:79]
    s_mov_b32 exec_lo, 0xf0000000
    s_mov_b32 exec_hi, 0xf0000000
    v_mov_b32 v160, v26
    v_mov_b32 v161, v26
    v_mov_b32 v162, v26
    v_mov_b32 v163, v26
    v_mov_b32 v164, v26
    v_mov_b32 v165, v26
    v_mov_b32 v166, v26
    v_mov_b32 v167, v26
    s_mov_b64 exec, -1
    buffer_store_dwordx4 v[160:163], v1, s[16:19], s30 offen sc0 sc1
    buffer_store_dwordx4 v[164:167], v1, s[16:19], s30 offen offset:1024 sc0 sc1
    ds_read_b64_tr_b16 v[100:101], v25 offset:16240
    ds_read_b64_tr_b16 v[102:103], v25 offset:16576
    s_waitcnt lgkmcnt(4)
    v_mfma_f32_32x32x16_bf16 v[64:79], v[148:151], v[92:95], v[64:79]
    s_waitcnt lgkmcnt(2)
    v_mfma_f32_32x32x16_bf16 v[64:79], v[152:155], v[96:99], v[64:79]
    s_waitcnt lgkmcnt(0)
    v_mfma_f32_32x32x16_bf16 v[64:79], v[156:159], v[100:103], v[64:79]
    s_nop 7
    s_nop 3
    v_cvt_pk_bf16_f32 v160, v64, v65
    v_cvt_pk_bf16_f32 v161, v66, v67
    v_cvt_pk_bf16_f32 v162, v68, v69
    v_cvt_pk_bf16_f32 v163, v70, v71
    v_cvt_pk_bf16_f32 v164, v72, v73
    v_cvt_pk_bf16_f32 v165, v74, v75
    v_cvt_pk_bf16_f32 v166, v76, v77
    v_cvt_pk_bf16_f32 v167, v78, v79
    s_mov_b32 exec_lo, 0xf0000000
    s_mov_b32 exec_hi, 0xf0000000
    v_mov_b32 v160, v26
    v_mov_b32 v161, v26
    v_mov_b32 v162, v26
    v_mov_b32 v163, v26
    v_mov_b32 v164, v26
    v_mov_b32 v165, v26
    v_mov_b32 v166, v26
    v_mov_b32 v167, v26
    s_mov_b64 exec, -1
    buffer_store_dwordx4 v[160:163], v1, s[16:19], s31 offen sc0 sc1
    buffer_store_dwordx4 v[164:167], v1, s[16:19], s31 offen offset:1024 sc0 sc1
    s_endpgm
L_k1_end:
    s_endpgm
.section .rodata,"a"
.p2align 6
.amdhsa_kernel qkv_kernel
  .amdhsa_next_free_vgpr 168
  .amdhsa_next_free_sgpr 96
  .amdhsa_accum_offset 168
  .amdhsa_group_segment_fixed_size 0
  .amdhsa_kernarg_size 72
  .amdhsa_user_sgpr_count 2
  .amdhsa_user_sgpr_kernarg_segment_ptr 1
  .amdhsa_system_sgpr_workgroup_id_x 1
.end_amdhsa_kernel
.text
.globl attn_kernel
.p2align 8
.type attn_kernel,@function
attn_kernel:
    s_cmp_ge_u32 s2, 256
    s_cbranch_scc1 L_k2_end
    s_load_dwordx2 s[8:9], s[0:1], 64
    v_lshrrev_b32 v242, 6, v0
    v_and_b32 v241, 63, v0
    v_readfirstlane_b32 s3, v242
    v_lshlrev_b32 v240, 4, v241
    s_and_b32 s34, s2, 7
    s_lshl_b32 s34, s34, 1
    s_bfe_u32 s35, s2, 0x10007
    s_add_u32 s4, s34, s35
    s_bfe_u32 s5, s2, 0x40003
    s_lshl_b32 s33, s4, 17
    s_mov_b32 s10, 16842752
    s_mov_b32 s11, 0x20000
    s_and_b32 s6, s3, 3
    s_lshl_b32 s34, s5, 2
    s_add_u32 s34, s34, s6
    s_lshl_b32 s23, s34, 11
    s_add_u32 s23, s23, s33
    s_cmp_ge_u32 s3, 4
    s_cbranch_scc1 L_k2_H
    s_lshl_b32 s37, s3, 15
    s_add_u32 s37, s37, s33
    s_add_u32 s16, s37, 8388608
    s_add_u32 s17, s37, 10485760
    s_add_u32 s52, s23, 6291456
    s_waitcnt lgkmcnt(0)
    s_and_b32 s9, s9, 0xffff
    buffer_load_dwordx4 v[0:3], v240, s[8:11], s52 offen
    buffer_load_dwordx4 v[144:147], v240, s[8:11], s16 offen
    buffer_load_dwordx4 v[4:7], v240, s[8:11], s52 offen offset:1024
    buffer_load_dwordx4 v[148:151], v240, s[8:11], s16 offen offset:1024
    s_sub_u32 s36, s23, 4096
    s_cmp_lt_u32 s34, 2
    s_cselect_b32 s36, s23, s36
    s_cselect_b32 s30, 0, -1
    s_add_u32 s24, s23, 2097152
    s_add_u32 s25, s36, 2097152
    s_add_u32 s26, s23, 4194304
    s_add_u32 s27, s36, 4194304
    s_lshl_b32 s36, s34, 15
    s_lshl_b32 s37, s4, 11
    s_add_u32 s36, s36, s37
    s_add_u32 s32, s36, 14680064
    s_add_u32 s21, s36, 12582912
    s_lshl_b32 s36, s34, 7
    s_lshl_b32 s37, s4, 2
    s_add_u32 s36, s36, s37
    s_add_u32 s31, s36, 16785408
    s_add_u32 s22, s36, 16777216
    s_mov_b32 s60, 0xff
    s_mov_b32 s61, 0xff0
    s_mov_b32 s62, 0x1fe
    s_mov_b32 s63, 0x1fe0
    s_mov_b32 s64, 0x3fc
    s_mov_b32 s65, 0x3fc0
    s_mov_b32 s66, 0x7f8
    s_mov_b32 s67, 0x7f80
    s_mov_b32 s68, 0xff00
    s_mov_b32 s69, 0xff000
    s_mov_b32 s70, 0x1fe00
    s_mov_b32 s71, 0x1fe000
    s_mov_b32 s72, 0x3fc00
    s_mov_b32 s73, 0x3fc000
    s_mov_b32 s74, 0x7f800
    s_mov_b32 s75, 0x7f8000
    s_mov_b32 s76, 0xff0000
    s_mov_b32 s77, 0xff00000
    s_mov_b32 s78, 0x1fe0000
    s_mov_b32 s79, 0x1fe00000
    s_mov_b32 s80, 0x3fc0000
    s_mov_b32 s81, 0x3fc00000
    s_mov_b32 s82, 0x7f80000
    s_mov_b32 s83, 0x7f800000
    s_mov_b32 s84, 0xff000000
    s_mov_b32 s85, 0xf0000000
    s_mov_b32 s86, 0xfe000000
    s_mov_b32 s87, 0xe0000000
    s_mov_b32 s88, 0xfc000000
    s_mov_b32 s89, 0xc0000000
    s_mov_b32 s90, 0xf8000000
    s_mov_b32 s91, 0x80000000
    s_and_b32 s92, s30, 0x0
    s_and_b32 s93, s30, 0xf
    s_and_b32 s94, s30, 0x1
    s_and_b32 s95, s30, 0x1f
    s_and_b32 s96, s30, 0x3
    s_and_b32 s97, s30, 0x3f
    s_and_b32 s98, s30, 0x7
    s_and_b32 s99, s30, 0x7f
    s_add_u32 s36, s3, 0
    s_and_b32 s36, s36, 3
    s_lshl_b32 s56, s36, 7
    s_lshl_b32 s36, s36, 11
    s_add_u32 s36, s36, 114688
    v_add_u32 v112, s36, v240
    s_add_u32 s36, s3, 1
    s_and_b32 s36, s36, 3
    s_lshl_b32 s57, s36, 7
    s_lshl_b32 s36, s36, 11
    s_add_u32 s36, s36, 114688
    v_add_u32 v113, s36, v240
    s_add_u32 s36, s3, 2
    s_and_b32 s36, s36, 3
    s_lshl_b32 s58, s36, 7
    s_lshl_b32 s36, s36, 11
    s_add_u32 s36, s36, 114688
    v_add_u32 v114, s36, v240
    s_add_u32 s36, s3, 3
    s_and_b32 s36, s36, 3
    s_lshl_b32 s59, s36, 7
    s_lshl_b32 s36, s36, 11
    s_add_u32 s36, s36, 114688
    v_add_u32 v115, s36, v240
    s_add_u32 s19, s16, 4096
    s_add_u32 s20, s17, 4096
    s_add_u32 s55, s16, 8192
    buffer_load_dwordx4 v[152:155], v240, s[8:11], s17 offen
    buffer_load_dwordx4 v[156:159], v240, s[8:11], s17 offen offset:1024
    buffer_load_dwordx4 v[160:163], v240, s[8:11], s16 offen offset:2048
    buffer_load_dwordx4 v[164:167], v240, s[8:11], s16 offen offset:3072
    v_mov_b32 v247, 1
    v_mov_b32 v246, 2130706432
    v_writelane_b32 v246, 0, 0
    v_mov_b32 v245, 0
    s_waitcnt vmcnt(4)
    v_mfma_f32_32x32x16_bf16 v[96:111], v[144:147], v[0:3], 0
    v_mfma_f32_32x32x16_bf16 v[96:111], v[148:151], v[4:7], v[96:111]
    ds_write_b128 v112, v[0:3]
    s_nop 7
    s_nop 2
    v_max3_f32 v242, v96, v97, v98
    v_max3_f32 v242, v242, v99, v100
    v_max3_f32 v242, v242, v101, v102
    v_max3_f32 v242, v242, v103, v104
    v_max3_f32 v242, v242, v105, v106
    v_max3_f32 v242, v242, v107, v108
    v_max3_f32 v242, v242, v109, v110
    v_max_f32 v242, v242, v111
    v_mov_b32 v243, v242
    s_nop 1
    v_permlane32_swap_b32 v242, v243
    s_nop 1
    v_max_f32 v242, v242, v243
    v_sub_f32 v242, 0xc2c80000, v242
    s_mov_b32 exec_lo, 0
    v_cvt_pk_bf16_f32 v6, v242, v245
    s_mov_b32 exec_lo, -1
    ds_write_b128 v112, v[4:7] offset:1024
    v_mfma_f32_32x32x16_bf16 v[96:111], v[144:147], v[0:3], 0
    v_mfma_f32_32x32x16_bf16 v[96:111], v[148:151], v[4:7], v[96:111]
    s_waitcnt lgkmcnt(0)
    s_barrier
    ds_read_b128 v[8:11], v113 offset:0
    ds_read_b128 v[12:15], v113 offset:1024
    ds_read_b128 v[16:19], v114 offset:0
    ds_read_b128 v[20:23], v114 offset:1024
    ds_read_b128 v[24:27], v115 offset:0
    ds_read_b128 v[28:31], v115 offset:1024
    s_nop 1
    s_waitcnt lgkmcnt(4)
    v_mfma_f32_32x32x16_bf16 v[112:127], v[144:147], v[8:11], 0
    buffer_load_dwordx4 v[168:171], v240, s[8:11], s17 offen offset:2048
    v_exp_f32 v96, v96
    v_exp_f32 v97, v97
    v_exp_f32 v98, v98
    v_exp_f32 v99, v99
    v_cvt_pk_bf16_f32 v128, v96, v97
    v_cvt_pk_bf16_f32 v129, v98, v99
    v_mfma_f32_32x32x16_bf16 v[112:127], v[148:151], v[12:15], v[112:127]
    s_waitcnt lgkmcnt(0)
    v_exp_f32 v100, v100
    v_exp_f32 v101, v101
    v_exp_f32 v102, v102
    v_exp_f32 v103, v103
    v_cvt_pk_bf16_f32 v130, v100, v101
    v_cvt_pk_bf16_f32 v131, v102, v103
    buffer_load_dwordx4 v[172:175], v240, s[8:11], s17 offen offset:3072
    v_exp_f32 v104, v104
    v_exp_f32 v105, v105
    v_exp_f32 v106, v106
    v_exp_f32 v107, v107
    v_cvt_pk_bf16_f32 v132, v104, v105
    v_cvt_pk_bf16_f32 v133, v106, v107
    buffer_load_dwordx4 v[176:179], v240, s[8:11], s19 offen
    v_exp_f32 v108, v108
    v_exp_f32 v109, v109
    v_exp_f32 v110, v110
    v_exp_f32 v111, v111
    v_cvt_pk_bf16_f32 v134, v108, v109
    v_cvt_pk_bf16_f32 v135, v110, v111
    v_mfma_f32_32x32x16_bf16 v[96:111], v[144:147], v[16:19], 0
    buffer_load_dwordx4 v[180:183], v240, s[8:11], s19 offen offset:1024
    v_exp_f32 v112, v112
    v_exp_f32 v113, v113
    v_exp_f32 v114, v114
    v_exp_f32 v115, v115
    v_cvt_pk_bf16_f32 v136, v112, v113
    v_cvt_pk_bf16_f32 v137, v114, v115
    v_mfma_f32_32x32x16_bf16 v[96:111], v[148:151], v[20:23], v[96:111]
    s_waitcnt vmcnt(6)
    v_exp_f32 v116, v116
    v_exp_f32 v117, v117
    v_exp_f32 v118, v118
    v_exp_f32 v119, v119
    v_cvt_pk_bf16_f32 v138, v116, v117
    v_cvt_pk_bf16_f32 v139, v118, v119
    v_mfma_f32_32x32x16_bf16 v[32:47], v[152:155], v[128:131], 0
    buffer_load_dwordx4 v[200:203], v240, s[8:11], s20 offen offset:2048
    v_exp_f32 v120, v120
    v_exp_f32 v121, v121
    v_exp_f32 v122, v122
    v_exp_f32 v123, v123
    v_cvt_pk_bf16_f32 v140, v120, v121
    v_cvt_pk_bf16_f32 v141, v122, v123
    v_mfma_f32_32x32x16_bf16 v[32:47], v[156:159], v[132:135], v[32:47]
    buffer_load_dwordx4 v[204:207], v240, s[8:11], s20 offen offset:3072
    v_exp_f32 v124, v124
    v_exp_f32 v125, v125
    v_exp_f32 v126, v126
    v_exp_f32 v127, v127
    v_cvt_pk_bf16_f32 v142, v124, v125
    v_cvt_pk_bf16_f32 v143, v126, v127
    v_mfma_f32_32x32x16_bf16 v[112:127], v[144:147], v[24:27], 0
    buffer_load_dwordx4 v[184:187], v240, s[8:11], s20 offen
    v_exp_f32 v96, v96
    v_exp_f32 v97, v97
    v_exp_f32 v98, v98
    v_exp_f32 v99, v99
    v_cvt_pk_bf16_f32 v128, v96, v97
    v_cvt_pk_bf16_f32 v129, v98, v99
    v_mfma_f32_32x32x16_bf16 v[112:127], v[148:151], v[28:31], v[112:127]
    buffer_load_dwordx4 v[188:191], v240, s[8:11], s20 offen offset:1024
    v_exp_f32 v100, v100
    v_exp_f32 v101, v101
    v_exp_f32 v102, v102
    v_exp_f32 v103, v103
    v_cvt_pk_bf16_f32 v130, v100, v101
    v_cvt_pk_bf16_f32 v131, v102, v103
    v_mfma_f32_32x32x16_bf16 v[48:63], v[152:155], v[136:139], 0
    buffer_load_dwordx4 v[192:195], v240, s[8:11], s19 offen offset:2048
    v_exp_f32 v104, v104
    v_exp_f32 v105, v105
    v_exp_f32 v106, v106
    v_exp_f32 v107, v107
    v_cvt_pk_bf16_f32 v132, v104, v105
    v_cvt_pk_bf16_f32 v133, v106, v107
    v_mfma_f32_32x32x16_bf16 v[48:63], v[156:159], v[140:143], v[48:63]
    s_waitcnt vmcnt(9)
    v_exp_f32 v108, v108
    v_exp_f32 v109, v109
    v_exp_f32 v110, v110
    v_exp_f32 v111, v111
    v_cvt_pk_bf16_f32 v134, v108, v109
    v_cvt_pk_bf16_f32 v135, v110, v111
    v_mfma_f32_32x32x16_bf16 v[96:111], v[160:163], v[0:3], 0
    buffer_load_dwordx4 v[144:147], v240, s[8:11], s55 offen
    v_exp_f32 v112, v112
    v_exp_f32 v113, v113
    v_exp_f32 v114, v114
    v_exp_f32 v115, v115
    v_cvt_pk_bf16_f32 v136, v112, v113
    v_cvt_pk_bf16_f32 v137, v114, v115
    v_mfma_f32_32x32x16_bf16 v[96:111], v[164:167], v[4:7], v[96:111]
    buffer_load_dwordx4 v[148:151], v240, s[8:11], s55 offen offset:1024
    v_exp_f32 v116, v116
    v_exp_f32 v117, v117
    v_exp_f32 v118, v118
    v_exp_f32 v119, v119
    v_cvt_pk_bf16_f32 v138, v116, v117
    v_cvt_pk_bf16_f32 v139, v118, v119
    v_mfma_f32_32x32x16_bf16 v[64:79], v[152:155], v[128:131], 0
    buffer_load_dwordx4 v[196:199], v240, s[8:11], s19 offen offset:3072
    v_exp_f32 v120, v120
    v_exp_f32 v121, v121
    v_exp_f32 v122, v122
    v_exp_f32 v123, v123
    v_cvt_pk_bf16_f32 v140, v120, v121
    v_cvt_pk_bf16_f32 v141, v122, v123
    v_mfma_f32_32x32x16_bf16 v[64:79], v[156:159], v[132:135], v[64:79]
    v_exp_f32 v124, v124
    v_exp_f32 v125, v125
    v_exp_f32 v126, v126
    v_exp_f32 v127, v127
    v_cvt_pk_bf16_f32 v142, v124, v125
    v_cvt_pk_bf16_f32 v143, v126, v127
    v_mfma_f32_32x32x16_bf16 v[112:127], v[160:163], v[8:11], 0
    s_add_u32 s20, s17, 8192
    v_exp_f32 v96, v96
    v_exp_f32 v97, v97
    v_exp_f32 v98, v98
    v_exp_f32 v99, v99
    v_cvt_pk_bf16_f32 v128, v96, v97
    v_cvt_pk_bf16_f32 v129, v98, v99
    v_mfma_f32_32x32x16_bf16 v[112:127], v[164:167], v[12:15], v[112:127]
    v_exp_f32 v100, v100
    v_exp_f32 v101, v101
    v_exp_f32 v102, v102
    v_exp_f32 v103, v103
    v_cvt_pk_bf16_f32 v130, v100, v101
    v_cvt_pk_bf16_f32 v131, v102, v103
    v_mfma_f32_32x32x16_bf16 v[80:95], v[152:155], v[136:139], 0
    buffer_load_dwordx4 v[208:211], v240, s[8:11], s23 offen
    v_exp_f32 v104, v104
    v_exp_f32 v105, v105
    v_exp_f32 v106, v106
    v_exp_f32 v107, v107
    v_cvt_pk_bf16_f32 v132, v104, v105
    v_cvt_pk_bf16_f32 v133, v106, v107
    v_mfma_f32_32x32x16_bf16 v[80:95], v[156:159], v[140:143], v[80:95]
    buffer_load_dwordx4 v[212:215], v240, s[8:11], s23 offen offset:1024
    v_exp_f32 v108, v108
    v_exp_f32 v109, v109
    v_exp_f32 v110, v110
    v_exp_f32 v111, v111
    v_cvt_pk_bf16_f32 v134, v108, v109
    v_cvt_pk_bf16_f32 v135, v110, v111
    v_mfma_f32_32x32x16_bf16 v[96:111], v[160:163], v[16:19], 0
    v_exp_f32 v112, v112
    v_exp_f32 v113, v113
    v_exp_f32 v114, v114
    v_exp_f32 v115, v115
    v_cvt_pk_bf16_f32 v136, v112, v113
    v_cvt_pk_bf16_f32 v137, v114, v115
    v_mfma_f32_32x32x16_bf16 v[96:111], v[164:167], v[20:23], v[96:111]
    s_waitcnt vmcnt(12)
    v_exp_f32 v116, v116
    v_exp_f32 v117, v117
    v_exp_f32 v118, v118
    v_exp_f32 v119, v119
    v_cvt_pk_bf16_f32 v138, v116, v117
    v_cvt_pk_bf16_f32 v139, v118, v119
    v_mfma_f32_32x32x16_bf16 v[32:47], v[168:171], v[128:131], v[32:47]
    buffer_load_dwordx4 v[152:155], v240, s[8:11], s20 offen
    v_exp_f32 v120, v120
    v_exp_f32 v121, v121
    v_exp_f32 v122, v122
    v_exp_f32 v123, v123
    v_cvt_pk_bf16_f32 v140, v120, v121
    v_cvt_pk_bf16_f32 v141, v122, v123
    v_mfma_f32_32x32x16_bf16 v[32:47], v[172:175], v[132:135], v[32:47]
    buffer_load_dwordx4 v[156:159], v240, s[8:11], s20 offen offset:1024
    v_exp_f32 v124, v124
    v_exp_f32 v125, v125
    v_exp_f32 v126, v126
    v_exp_f32 v127, v127
    v_cvt_pk_bf16_f32 v142, v124, v125
    v_cvt_pk_bf16_f32 v143, v126, v127
    v_mfma_f32_32x32x16_bf16 v[112:127], v[160:163], v[24:27], 0
    buffer_load_dwordx4 v[216:219], v240, s[8:11], s24 offen
    v_exp_f32 v96, v96
    v_exp_f32 v97, v97
    v_exp_f32 v98, v98
    v_exp_f32 v99, v99
    v_cvt_pk_bf16_f32 v128, v96, v97
    v_cvt_pk_bf16_f32 v129, v98, v99
    v_mfma_f32_32x32x16_bf16 v[112:127], v[164:167], v[28:31], v[112:127]
    buffer_load_dwordx4 v[220:223], v240, s[8:11], s24 offen offset:1024
    v_exp_f32 v100, v100
    v_exp_f32 v101, v101
    v_exp_f32 v102, v102
    v_exp_f32 v103, v103
    v_cvt_pk_bf16_f32 v130, v100, v101
    v_cvt_pk_bf16_f32 v131, v102, v103
    v_mfma_f32_32x32x16_bf16 v[48:63], v[168:171], v[136:139], v[48:63]
    buffer_load_dwordx4 v[224:227], v240, s[8:11], s25 offen
    v_exp_f32 v104, v104
    v_exp_f32 v105, v105
    v_exp_f32 v106, v106
    v_exp_f32 v107, v107
    v_cvt_pk_bf16_f32 v132, v104, v105
    v_cvt_pk_bf16_f32 v133, v106, v107
    v_mfma_f32_32x32x16_bf16 v[48:63], v[172:175], v[140:143], v[48:63]
    s_waitcnt vmcnt(15)
    v_exp_f32 v108, v108
    v_exp_f32 v109, v109
    v_exp_f32 v110, v110
    v_exp_f32 v111, v111
    v_cvt_pk_bf16_f32 v134, v108, v109
    v_cvt_pk_bf16_f32 v135, v110, v111
    v_mfma_f32_32x32x16_bf16 v[96:111], v[176:179], v[0:3], 0
    buffer_load_dwordx4 v[160:163], v240, s[8:11], s55 offen offset:2048
    v_exp_f32 v112, v112
    v_exp_f32 v113, v113
    v_exp_f32 v114, v114
    v_exp_f32 v115, v115
    v_cvt_pk_bf16_f32 v136, v112, v113
    v_cvt_pk_bf16_f32 v137, v114, v115
    v_mfma_f32_32x32x16_bf16 v[96:111], v[180:183], v[4:7], v[96:111]
    buffer_load_dwordx4 v[164:167], v240, s[8:11], s55 offen offset:3072
    v_exp_f32 v116, v116
    v_exp_f32 v117, v117
    v_exp_f32 v118, v118
    v_exp_f32 v119, v119
    v_cvt_pk_bf16_f32 v138, v116, v117
    v_cvt_pk_bf16_f32 v139, v118, v119
    v_mfma_f32_32x32x16_bf16 v[64:79], v[168:171], v[128:131], v[64:79]
    v_exp_f32 v120, v120
    v_exp_f32 v121, v121
    v_exp_f32 v122, v122
    v_exp_f32 v123, v123
    v_cvt_pk_bf16_f32 v140, v120, v121
    v_cvt_pk_bf16_f32 v141, v122, v123
    v_mfma_f32_32x32x16_bf16 v[64:79], v[172:175], v[132:135], v[64:79]
    v_exp_f32 v124, v124
    v_exp_f32 v125, v125
    v_exp_f32 v126, v126
    v_exp_f32 v127, v127
    v_cvt_pk_bf16_f32 v142, v124, v125
    v_cvt_pk_bf16_f32 v143, v126, v127
    v_mfma_f32_32x32x16_bf16 v[112:127], v[176:179], v[8:11], 0
    v_exp_f32 v96, v96
    v_exp_f32 v97, v97
    v_exp_f32 v98, v98
    v_exp_f32 v99, v99
    v_cvt_pk_bf16_f32 v128, v96, v97
    v_cvt_pk_bf16_f32 v129, v98, v99
    v_mfma_f32_32x32x16_bf16 v[112:127], v[180:183], v[12:15], v[112:127]
    s_add_u32 s55, s16, 12288
    v_exp_f32 v100, v100
    v_exp_f32 v101, v101
    v_exp_f32 v102, v102
    v_exp_f32 v103, v103
    v_cvt_pk_bf16_f32 v130, v100, v101
    v_cvt_pk_bf16_f32 v131, v102, v103
    v_mfma_f32_32x32x16_bf16 v[80:95], v[168:171], v[136:139], v[80:95]
    buffer_load_dwordx4 v[228:231], v240, s[8:11], s25 offen offset:1024
    v_exp_f32 v104, v104
    v_exp_f32 v105, v105
    v_exp_f32 v106, v106
    v_exp_f32 v107, v107
    v_cvt_pk_bf16_f32 v132, v104, v105
    v_cvt_pk_bf16_f32 v133, v106, v107
    v_mfma_f32_32x32x16_bf16 v[80:95], v[172:175], v[140:143], v[80:95]
    buffer_load_dwordx4 v[232:235], v240, s[8:11], s26 offen
    v_exp_f32 v108, v108
    v_exp_f32 v109, v109
    v_exp_f32 v110, v110
    v_exp_f32 v111, v111
    v_cvt_pk_bf16_f32 v134, v108, v109
    v_cvt_pk_bf16_f32 v135, v110, v111
    v_mfma_f32_32x32x16_bf16 v[96:111], v[176:179], v[16:19], 0
    v_exp_f32 v112, v112
    v_exp_f32 v113, v113
    v_exp_f32 v114, v114
    v_exp_f32 v115, v115
    v_cvt_pk_bf16_f32 v136, v112, v113
    v_cvt_pk_bf16_f32 v137, v114, v115
    v_mfma_f32_32x32x16_bf16 v[96:111], v[180:183], v[20:23], v[96:111]
    s_waitcnt vmcnt(15)
    v_exp_f32 v116, v116
    v_exp_f32 v117, v117
    v_exp_f32 v118, v118
    v_exp_f32 v119, v119
    v_cvt_pk_bf16_f32 v138, v116, v117
    v_cvt_pk_bf16_f32 v139, v118, v119
    v_mfma_f32_32x32x16_bf16 v[32:47], v[184:187], v[128:131], v[32:47]
    buffer_load_dwordx4 v[168:171], v240, s[8:11], s20 offen offset:2048
    v_exp_f32 v120, v120
    v_exp_f32 v121, v121
    v_exp_f32 v122, v122
    v_exp_f32 v123, v123
    v_cvt_pk_bf16_f32 v140, v120, v121
    v_cvt_pk_bf16_f32 v141, v122, v123
    v_mfma_f32_32x32x16_bf16 v[32:47], v[188:191], v[132:135], v[32:47]
    buffer_load_dwordx4 v[172:175], v240, s[8:11], s20 offen offset:3072
    v_exp_f32 v124, v124
    v_exp_f32 v125, v125
    v_exp_f32 v126, v126
    v_exp_f32 v127, v127
    v_cvt_pk_bf16_f32 v142, v124, v125
    v_cvt_pk_bf16_f32 v143, v126, v127
    v_mfma_f32_32x32x16_bf16 v[112:127], v[176:179], v[24:27], 0
    buffer_load_dwordx4 v[236:239], v240, s[8:11], s26 offen offset:1024
    v_exp_f32 v96, v96
    v_exp_f32 v97, v97
    v_exp_f32 v98, v98
    v_exp_f32 v99, v99
    v_cvt_pk_bf16_f32 v128, v96, v97
    v_cvt_pk_bf16_f32 v129, v98, v99
    v_mfma_f32_32x32x16_bf16 v[112:127], v[180:183], v[28:31], v[112:127]
    buffer_load_dwordx4 v[248:251], v240, s[8:11], s27 offen offset:1024
    v_exp_f32 v100, v100
    v_exp_f32 v101, v101
    v_exp_f32 v102, v102
    v_exp_f32 v103, v103
    v_cvt_pk_bf16_f32 v130, v100, v101
    v_cvt_pk_bf16_f32 v131, v102, v103
    v_mfma_f32_32x32x16_bf16 v[48:63], v[184:187], v[136:139], v[48:63]
    v_exp_f32 v104, v104
    v_exp_f32 v105, v105
    v_exp_f32 v106, v106
    v_exp_f32 v107, v107
    v_cvt_pk_bf16_f32 v132, v104, v105
    v_cvt_pk_bf16_f32 v133, v106, v107
    v_mfma_f32_32x32x16_bf16 v[48:63], v[188:191], v[140:143], v[48:63]
    s_waitcnt vmcnt(15)
    v_exp_f32 v108, v108
    v_exp_f32 v109, v109
    v_exp_f32 v110, v110
    v_exp_f32 v111, v111
    v_cvt_pk_bf16_f32 v134, v108, v109
    v_cvt_pk_bf16_f32 v135, v110, v111
    v_mfma_f32_32x32x16_bf16 v[96:111], v[192:195], v[0:3], 0
    buffer_load_dwordx4 v[176:179], v240, s[8:11], s55 offen
    v_exp_f32 v112, v112
    v_exp_f32 v113, v113
    v_exp_f32 v114, v114
    v_exp_f32 v115, v115
    v_cvt_pk_bf16_f32 v136, v112, v113
    v_cvt_pk_bf16_f32 v137, v114, v115
    v_mfma_f32_32x32x16_bf16 v[96:111], v[196:199], v[4:7], v[96:111]
    buffer_load_dwordx4 v[180:183], v240, s[8:11], s55 offen offset:1024
    v_exp_f32 v116, v116
    v_exp_f32 v117, v117
    v_exp_f32 v118, v118
    v_exp_f32 v119, v119
    v_cvt_pk_bf16_f32 v138, v116, v117
    v_cvt_pk_bf16_f32 v139, v118, v119
    v_mfma_f32_32x32x16_bf16 v[64:79], v[184:187], v[128:131], v[64:79]
    v_exp_f32 v120, v120
    v_exp_f32 v121, v121
    v_exp_f32 v122, v122
    v_exp_f32 v123, v123
    v_cvt_pk_bf16_f32 v140, v120, v121
    v_cvt_pk_bf16_f32 v141, v122, v123
    v_mfma_f32_32x32x16_bf16 v[64:79], v[188:191], v[132:135], v[64:79]
    v_exp_f32 v124, v124
    v_exp_f32 v125, v125
    v_exp_f32 v126, v126
    v_exp_f32 v127, v127
    v_cvt_pk_bf16_f32 v142, v124, v125
    v_cvt_pk_bf16_f32 v143, v126, v127
    v_mfma_f32_32x32x16_bf16 v[112:127], v[192:195], v[8:11], 0
    s_add_u32 s20, s17, 12288
    v_exp_f32 v96, v96
    v_exp_f32 v97, v97
    v_exp_f32 v98, v98
    v_exp_f32 v99, v99
    v_cvt_pk_bf16_f32 v128, v96, v97
    v_cvt_pk_bf16_f32 v129, v98, v99
    v_mfma_f32_32x32x16_bf16 v[112:127], v[196:199], v[12:15], v[112:127]
    v_exp_f32 v100, v100
    v_exp_f32 v101, v101
    v_exp_f32 v102, v102
    v_exp_f32 v103, v103
    v_cvt_pk_bf16_f32 v130, v100, v101
    v_cvt_pk_bf16_f32 v131, v102, v103
    v_mfma_f32_32x32x16_bf16 v[80:95], v[184:187], v[136:139], v[80:95]
    v_exp_f32 v104, v104
    v_exp_f32 v105, v105
    v_exp_f32 v106, v106
    v_exp_f32 v107, v107
    v_cvt_pk_bf16_f32 v132, v104, v105
    v_cvt_pk_bf16_f32 v133, v106, v107
    v_mfma_f32_32x32x16_bf16 v[80:95], v[188:191], v[140:143], v[80:95]
    v_exp_f32 v108, v108
    v_exp_f32 v109, v109
    v_exp_f32 v110, v110
    v_exp_f32 v111, v111
    v_cvt_pk_bf16_f32 v134, v108, v109
    v_cvt_pk_bf16_f32 v135, v110, v111
    v_mfma_f32_32x32x16_bf16 v[96:111], v[192:195], v[16:19], 0
    v_exp_f32 v112, v112
    v_exp_f32 v113, v113
    v_exp_f32 v114, v114
    v_exp_f32 v115, v115
    v_cvt_pk_bf16_f32 v136, v112, v113
    v_cvt_pk_bf16_f32 v137, v114, v115
    v_mfma_f32_32x32x16_bf16 v[96:111], v[196:199], v[20:23], v[96:111]
    v_exp_f32 v116, v116
    v_exp_f32 v117, v117
    v_exp_f32 v118, v118
    v_exp_f32 v119, v119
    v_cvt_pk_bf16_f32 v138, v116, v117
    v_cvt_pk_bf16_f32 v139, v118, v119
    v_mfma_f32_32x32x16_bf16 v[32:47], v[200:203], v[128:131], v[32:47]
    buffer_load_dwordx4 v[184:187], v240, s[8:11], s20 offen
    v_exp_f32 v120, v120
    v_exp_f32 v121, v121
    v_exp_f32 v122, v122
    v_exp_f32 v123, v123
    v_cvt_pk_bf16_f32 v140, v120, v121
    v_cvt_pk_bf16_f32 v141, v122, v123
    v_mfma_f32_32x32x16_bf16 v[32:47], v[204:207], v[132:135], v[32:47]
    buffer_load_dwordx4 v[188:191], v240, s[8:11], s20 offen offset:1024
    v_exp_f32 v124, v124
    v_exp_f32 v125, v125
    v_exp_f32 v126, v126
    v_exp_f32 v127, v127
    v_cvt_pk_bf16_f32 v142, v124, v125
    v_cvt_pk_bf16_f32 v143, v126, v127
    v_mfma_f32_32x32x16_bf16 v[112:127], v[192:195], v[24:27], 0
    v_exp_f32 v96, v96
    v_exp_f32 v97, v97
    v_exp_f32 v98, v98
    v_exp_f32 v99, v99
    v_cvt_pk_bf16_f32 v128, v96, v97
    v_cvt_pk_bf16_f32 v129, v98, v99
    v_mfma_f32_32x32x16_bf16 v[112:127], v[196:199], v[28:31], v[112:127]
    v_exp_f32 v100, v100
    v_exp_f32 v101, v101
    v_exp_f32 v102, v102
    v_exp_f32 v103, v103
    v_cvt_pk_bf16_f32 v130, v100, v101
    v_cvt_pk_bf16_f32 v131, v102, v103
    v_mfma_f32_32x32x16_bf16 v[48:63], v[200:203], v[136:139], v[48:63]
    v_exp_f32 v104, v104
    v_exp_f32 v105, v105
    v_exp_f32 v106, v106
    v_exp_f32 v107, v107
    v_cvt_pk_bf16_f32 v132, v104, v105
    v_cvt_pk_bf16_f32 v133, v106, v107
    v_mfma_f32_32x32x16_bf16 v[48:63], v[204:207], v[140:143], v[48:63]
    v_exp_f32 v108, v108
    v_exp_f32 v109, v109
    v_exp_f32 v110, v110
    v_exp_f32 v111, v111
    v_cvt_pk_bf16_f32 v134, v108, v109
    v_cvt_pk_bf16_f32 v135, v110, v111
    v_mfma_f32_32x32x16_bf16 v[96:111], v[144:147], v[0:3], 0
    buffer_load_dwordx4 v[192:195], v240, s[8:11], s55 offen offset:2048
    v_exp_f32 v112, v112
    v_exp_f32 v113, v113
    v_exp_f32 v114, v114
    v_exp_f32 v115, v115
    v_cvt_pk_bf16_f32 v136, v112, v113
    v_cvt_pk_bf16_f32 v137, v114, v115
    v_mfma_f32_32x32x16_bf16 v[96:111], v[148:151], v[4:7], v[96:111]
    buffer_load_dwordx4 v[196:199], v240, s[8:11], s55 offen offset:3072
    v_exp_f32 v116, v116
    v_exp_f32 v117, v117
    v_exp_f32 v118, v118
    v_exp_f32 v119, v119
    v_cvt_pk_bf16_f32 v138, v116, v117
    v_cvt_pk_bf16_f32 v139, v118, v119
    v_mfma_f32_32x32x16_bf16 v[64:79], v[200:203], v[128:131], v[64:79]
    v_exp_f32 v120, v120
    v_exp_f32 v121, v121
    v_exp_f32 v122, v122
    v_exp_f32 v123, v123
    v_cvt_pk_bf16_f32 v140, v120, v121
    v_cvt_pk_bf16_f32 v141, v122, v123
    v_mfma_f32_32x32x16_bf16 v[64:79], v[204:207], v[132:135], v[64:79]
    v_exp_f32 v124, v124
    v_exp_f32 v125, v125
    v_exp_f32 v126, v126
    v_exp_f32 v127, v127
    v_cvt_pk_bf16_f32 v142, v124, v125
    v_cvt_pk_bf16_f32 v143, v126, v127
    v_mfma_f32_32x32x16_bf16 v[112:127], v[144:147], v[8:11], 0
    v_exp_f32 v96, v96
    v_exp_f32 v97, v97
    v_exp_f32 v98, v98
    v_exp_f32 v99, v99
    v_cvt_pk_bf16_f32 v128, v96, v97
    v_cvt_pk_bf16_f32 v129, v98, v99
    v_mfma_f32_32x32x16_bf16 v[112:127], v[148:151], v[12:15], v[112:127]
    s_add_u32 s55, s16, 16384
    v_exp_f32 v100, v100
    v_exp_f32 v101, v101
    v_exp_f32 v102, v102
    v_exp_f32 v103, v103
    v_cvt_pk_bf16_f32 v130, v100, v101
    v_cvt_pk_bf16_f32 v131, v102, v103
    v_mfma_f32_32x32x16_bf16 v[80:95], v[200:203], v[136:139], v[80:95]
    v_exp_f32 v104, v104
    v_exp_f32 v105, v105
    v_exp_f32 v106, v106
    v_exp_f32 v107, v107
    v_cvt_pk_bf16_f32 v132, v104, v105
    v_cvt_pk_bf16_f32 v133, v106, v107
    v_mfma_f32_32x32x16_bf16 v[80:95], v[204:207], v[140:143], v[80:95]
    v_exp_f32 v108, v108
    v_exp_f32 v109, v109
    v_exp_f32 v110, v110
    v_exp_f32 v111, v111
    v_cvt_pk_bf16_f32 v134, v108, v109
    v_cvt_pk_bf16_f32 v135, v110, v111
    v_mfma_f32_32x32x16_bf16 v[96:111], v[144:147], v[16:19], 0
    v_exp_f32 v112, v112
    v_exp_f32 v113, v113
    v_exp_f32 v114, v114
    v_exp_f32 v115, v115
    v_cvt_pk_bf16_f32 v136, v112, v113
    v_cvt_pk_bf16_f32 v137, v114, v115
    v_mfma_f32_32x32x16_bf16 v[96:111], v[148:151], v[20:23], v[96:111]
    s_waitcnt vmcnt(17)
    v_exp_f32 v116, v116
    v_exp_f32 v117, v117
    v_exp_f32 v118, v118
    v_exp_f32 v119, v119
    v_cvt_pk_bf16_f32 v138, v116, v117
    v_cvt_pk_bf16_f32 v139, v118, v119
    v_mfma_f32_32x32x16_bf16 v[32:47], v[152:155], v[128:131], v[32:47]
    buffer_load_dwordx4 v[200:203], v240, s[8:11], s20 offen offset:2048
    v_exp_f32 v120, v120
    v_exp_f32 v121, v121
    v_exp_f32 v122, v122
    v_exp_f32 v123, v123
    v_cvt_pk_bf16_f32 v140, v120, v121
    v_cvt_pk_bf16_f32 v141, v122, v123
    v_mfma_f32_32x32x16_bf16 v[32:47], v[156:159], v[132:135], v[32:47]
    buffer_load_dwordx4 v[204:207], v240, s[8:11], s20 offen offset:3072
    v_exp_f32 v124, v124
    v_exp_f32 v125, v125
    v_exp_f32 v126, v126
    v_exp_f32 v127, v127
    v_cvt_pk_bf16_f32 v142, v124, v125
    v_cvt_pk_bf16_f32 v143, v126, v127
    v_mfma_f32_32x32x16_bf16 v[112:127], v[144:147], v[24:27], 0
    v_exp_f32 v96, v96
    v_exp_f32 v97, v97
    v_exp_f32 v98, v98
    v_exp_f32 v99, v99
    v_cvt_pk_bf16_f32 v128, v96, v97
    v_cvt_pk_bf16_f32 v129, v98, v99
    v_mfma_f32_32x32x16_bf16 v[112:127], v[148:151], v[28:31], v[112:127]
    v_exp_f32 v100, v100
    v_exp_f32 v101, v101
    v_exp_f32 v102, v102
    v_exp_f32 v103, v103
    v_cvt_pk_bf16_f32 v130, v100, v101
    v_cvt_pk_bf16_f32 v131, v102, v103
    v_mfma_f32_32x32x16_bf16 v[48:63], v[152:155], v[136:139], v[48:63]
    v_exp_f32 v104, v104
    v_exp_f32 v105, v105
    v_exp_f32 v106, v106
    v_exp_f32 v107, v107
    v_cvt_pk_bf16_f32 v132, v104, v105
    v_cvt_pk_bf16_f32 v133, v106, v107
    v_mfma_f32_32x32x16_bf16 v[48:63], v[156:159], v[140:143], v[48:63]
    s_waitcnt vmcnt(14)
    v_exp_f32 v108, v108
    v_exp_f32 v109, v109
    v_exp_f32 v110, v110
    v_exp_f32 v111, v111
    v_cvt_pk_bf16_f32 v134, v108, v109
    v_cvt_pk_bf16_f32 v135, v110, v111
    v_mfma_f32_32x32x16_bf16 v[96:111], v[160:163], v[0:3], 0
    buffer_load_dwordx4 v[144:147], v240, s[8:11], s55 offen
    v_exp_f32 v112, v112
    v_exp_f32 v113, v113
    v_exp_f32 v114, v114
    v_exp_f32 v115, v115
    v_cvt_pk_bf16_f32 v136, v112, v113
    v_cvt_pk_bf16_f32 v137, v114, v115
    v_mfma_f32_32x32x16_bf16 v[96:111], v[164:167], v[4:7], v[96:111]
    buffer_load_dwordx4 v[148:151], v240, s[8:11], s55 offen offset:1024
    v_exp_f32 v116, v116
    v_exp_f32 v117, v117
    v_exp_f32 v118, v118
    v_exp_f32 v119, v119
    v_cvt_pk_bf16_f32 v138, v116, v117
    v_cvt_pk_bf16_f32 v139, v118, v119
    v_mfma_f32_32x32x16_bf16 v[64:79], v[152:155], v[128:131], v[64:79]
    v_exp_f32 v120, v120
    v_exp_f32 v121, v121
    v_exp_f32 v122, v122
    v_exp_f32 v123, v123
    v_cvt_pk_bf16_f32 v140, v120, v121
    v_cvt_pk_bf16_f32 v141, v122, v123
    v_mfma_f32_32x32x16_bf16 v[64:79], v[156:159], v[132:135], v[64:79]
    v_exp_f32 v124, v124
    v_exp_f32 v125, v125
    v_exp_f32 v126, v126
    v_exp_f32 v127, v127
    v_cvt_pk_bf16_f32 v142, v124, v125
    v_cvt_pk_bf16_f32 v143, v126, v127
    v_mfma_f32_32x32x16_bf16 v[112:127], v[160:163], v[8:11], 0
    s_add_u32 s20, s17, 16384
    v_exp_f32 v96, v96
    v_exp_f32 v97, v97
    v_exp_f32 v98, v98
    v_exp_f32 v99, v99
    v_cvt_pk_bf16_f32 v128, v96, v97
    v_cvt_pk_bf16_f32 v129, v98, v99
    v_mfma_f32_32x32x16_bf16 v[112:127], v[164:167], v[12:15], v[112:127]
    v_exp_f32 v100, v100
    v_exp_f32 v101, v101
    v_exp_f32 v102, v102
    v_exp_f32 v103, v103
    v_cvt_pk_bf16_f32 v130, v100, v101
    v_cvt_pk_bf16_f32 v131, v102, v103
    v_mfma_f32_32x32x16_bf16 v[80:95], v[152:155], v[136:139], v[80:95]
    v_exp_f32 v104, v104
    v_exp_f32 v105, v105
    v_exp_f32 v106, v106
    v_exp_f32 v107, v107
    v_cvt_pk_bf16_f32 v132, v104, v105
    v_cvt_pk_bf16_f32 v133, v106, v107
    v_mfma_f32_32x32x16_bf16 v[80:95], v[156:159], v[140:143], v[80:95]
    v_exp_f32 v108, v108
    v_exp_f32 v109, v109
    v_exp_f32 v110, v110
    v_exp_f32 v111, v111
    v_cvt_pk_bf16_f32 v134, v108, v109
    v_cvt_pk_bf16_f32 v135, v110, v111
    v_mfma_f32_32x32x16_bf16 v[96:111], v[160:163], v[16:19], 0
    v_exp_f32 v112, v112
    v_exp_f32 v113, v113
    v_exp_f32 v114, v114
    v_exp_f32 v115, v115
    v_cvt_pk_bf16_f32 v136, v112, v113
    v_cvt_pk_bf16_f32 v137, v114, v115
    v_mfma_f32_32x32x16_bf16 v[96:111], v[164:167], v[20:23], v[96:111]
    s_waitcnt vmcnt(12)
    v_exp_f32 v116, v116
    v_exp_f32 v117, v117
    v_exp_f32 v118, v118
    v_exp_f32 v119, v119
    v_cvt_pk_bf16_f32 v138, v116, v117
    v_cvt_pk_bf16_f32 v139, v118, v119
    v_mfma_f32_32x32x16_bf16 v[32:47], v[168:171], v[128:131], v[32:47]
    buffer_load_dwordx4 v[152:155], v240, s[8:11], s20 offen
    v_exp_f32 v120, v120
    v_exp_f32 v121, v121
    v_exp_f32 v122, v122
    v_exp_f32 v123, v123
    v_cvt_pk_bf16_f32 v140, v120, v121
    v_cvt_pk_bf16_f32 v141, v122, v123
    v_mfma_f32_32x32x16_bf16 v[32:47], v[172:175], v[132:135], v[32:47]
    buffer_load_dwordx4 v[156:159], v240, s[8:11], s20 offen offset:1024
    v_exp_f32 v124, v124
    v_exp_f32 v125, v125
    v_exp_f32 v126, v126
    v_exp_f32 v127, v127
    v_cvt_pk_bf16_f32 v142, v124, v125
    v_cvt_pk_bf16_f32 v143, v126, v127
    v_mfma_f32_32x32x16_bf16 v[112:127], v[160:163], v[24:27], 0
    v_exp_f32 v96, v96
    v_exp_f32 v97, v97
    v_exp_f32 v98, v98
    v_exp_f32 v99, v99
    v_cvt_pk_bf16_f32 v128, v96, v97
    v_cvt_pk_bf16_f32 v129, v98, v99
    v_mfma_f32_32x32x16_bf16 v[112:127], v[164:167], v[28:31], v[112:127]
    v_exp_f32 v100, v100
    v_exp_f32 v101, v101
    v_exp_f32 v102, v102
    v_exp_f32 v103, v103
    v_cvt_pk_bf16_f32 v130, v100, v101
    v_cvt_pk_bf16_f32 v131, v102, v103
    v_mfma_f32_32x32x16_bf16 v[48:63], v[168:171], v[136:139], v[48:63]
    v_exp_f32 v104, v104
    v_exp_f32 v105, v105
    v_exp_f32 v106, v106
    v_exp_f32 v107, v107
    v_cvt_pk_bf16_f32 v132, v104, v105
    v_cvt_pk_bf16_f32 v133, v106, v107
    v_mfma_f32_32x32x16_bf16 v[48:63], v[172:175], v[140:143], v[48:63]
    s_waitcnt vmcnt(10)
    v_exp_f32 v108, v108
    v_exp_f32 v109, v109
    v_exp_f32 v110, v110
    v_exp_f32 v111, v111
    v_cvt_pk_bf16_f32 v134, v108, v109
    v_cvt_pk_bf16_f32 v135, v110, v111
    buffer_load_dwordx4 v[160:163], v240, s[8:11], s55 offen offset:2048
    v_exp_f32 v112, v112
    v_exp_f32 v113, v113
    v_exp_f32 v114, v114
    v_exp_f32 v115, v115
    v_cvt_pk_bf16_f32 v136, v112, v113
    v_cvt_pk_bf16_f32 v137, v114, v115
    buffer_load_dwordx4 v[164:167], v240, s[8:11], s55 offen offset:3072
    v_exp_f32 v116, v116
    v_exp_f32 v117, v117
    v_exp_f32 v118, v118
    v_exp_f32 v119, v119
    v_cvt_pk_bf16_f32 v138, v116, v117
    v_cvt_pk_bf16_f32 v139, v118, v119
    v_mfma_f32_32x32x16_bf16 v[64:79], v[168:171], v[128:131], v[64:79]
    v_exp_f32 v120, v120
    v_exp_f32 v121, v121
    v_exp_f32 v122, v122
    v_exp_f32 v123, v123
    v_cvt_pk_bf16_f32 v140, v120, v121
    v_cvt_pk_bf16_f32 v141, v122, v123
    v_mfma_f32_32x32x16_bf16 v[64:79], v[172:175], v[132:135], v[64:79]
    v_exp_f32 v124, v124
    v_exp_f32 v125, v125
    v_exp_f32 v126, v126
    v_exp_f32 v127, v127
    v_cvt_pk_bf16_f32 v142, v124, v125
    v_cvt_pk_bf16_f32 v143, v126, v127
    s_nop 0
    v_mfma_f32_32x32x16_bf16 v[80:95], v[168:171], v[136:139], v[80:95]
    v_mfma_f32_32x32x16_bf16 v[80:95], v[172:175], v[140:143], v[80:95]
    s_waitcnt vmcnt(14)
    v_mfma_f32_32x32x16_bf16 v[96:111], v[216:219], v[208:211], 0
    v_mfma_f32_32x32x16_bf16 v[96:111], v[220:223], v[212:215], v[96:111]
    v_mfma_f32_32x32x16_bf16 v[112:127], v[224:227], v[208:211], 0
    v_mfma_f32_32x32x16_bf16 v[112:127], v[228:231], v[212:215], v[112:127]
    v_mov_b32 v245, 0xf149f2ca
    v_mov_b32 v136, 0
    v_mov_b32 v137, 0
    s_nop 6
    v_cndmask_b32 v96, v245, v96, s[60:61]
    v_cndmask_b32 v97, v245, v97, s[62:63]
    v_cndmask_b32 v98, v245, v98, s[64:65]
    v_cndmask_b32 v99, v245, v99, s[66:67]
    v_cndmask_b32 v100, v245, v100, s[68:69]
    v_cndmask_b32 v101, v245, v101, s[70:71]
    v_cndmask_b32 v102, v245, v102, s[72:73]
    v_cndmask_b32 v103, v245, v103, s[74:75]
    v_cndmask_b32 v104, v245, v104, s[76:77]
    v_cndmask_b32 v105, v245, v105, s[78:79]
    v_cndmask_b32 v106, v245, v106, s[80:81]
    v_cndmask_b32 v107, v245, v107, s[82:83]
    v_cndmask_b32 v108, v245, v108, s[84:85]
    v_cndmask_b32 v109, v245, v109, s[86:87]
    v_cndmask_b32 v110, v245, v110, s[88:89]
    v_cndmask_b32 v111, v245, v111, s[90:91]
    v_cndmask_b32 v124, v245, v124, s[92:93]
    v_cndmask_b32 v125, v245, v125, s[94:95]
    v_cndmask_b32 v126, v245, v126, s[96:97]
    v_cndmask_b32 v127, v245, v127, s[98:99]
    v_max3_f32 v242, v96, v97, v98
    v_max3_f32 v242, v242, v99, v100
    v_max3_f32 v242, v242, v101, v102
    v_max3_f32 v242, v242, v103, v104
    v_max3_f32 v242, v242, v105, v106
    v_max3_f32 v242, v242, v107, v108
    v_max3_f32 v242, v242, v109, v110
    v_max3_f32 v242, v242, v111, v124
    v_max3_f32 v242, v242, v125, v126
    v_max_f32 v242, v242, v127
    v_mov_b32 v243, v242
    s_nop 1
    v_permlane32_swap_b32 v242, v243
    s_nop 1
    v_max_f32 v242, v242, v243
    v_sub_f32 v96, v96, v242
    v_sub_f32 v97, v97, v242
    v_sub_f32 v98, v98, v242
    v_sub_f32 v99, v99, v242
    v_sub_f32 v100, v100, v242
    v_sub_f32 v101, v101, v242
    v_sub_f32 v102, v102, v242
    v_sub_f32 v103, v103, v242
    v_sub_f32 v104, v104, v242
    v_sub_f32 v105, v105, v242
    v_sub_f32 v106, v106, v242
    v_sub_f32 v107, v107, v242
    v_sub_f32 v108, v108, v242
    v_sub_f32 v109, v109, v242
    v_sub_f32 v110, v110, v242
    v_sub_f32 v111, v111, v242
    v_sub_f32 v124, v124, v242
    v_sub_f32 v125, v125, v242
    v_sub_f32 v126, v126, v242
    v_sub_f32 v127, v127, v242
    v_exp_f32 v96, v96
    v_exp_f32 v97, v97
    v_exp_f32 v98, v98
    v_exp_f32 v99, v99
    v_exp_f32 v100, v100
    v_exp_f32 v101, v101
    v_exp_f32 v102, v102
    v_exp_f32 v103, v103
    v_exp_f32 v104, v104
    v_exp_f32 v105, v105
    v_exp_f32 v106, v106
    v_exp_f32 v107, v107
    v_exp_f32 v108, v108
    v_exp_f32 v109, v109
    v_exp_f32 v110, v110
    v_exp_f32 v111, v111
    v_exp_f32 v124, v124
    v_exp_f32 v125, v125
    v_exp_f32 v126, v126
    v_exp_f32 v127, v127
    v_cvt_pk_bf16_f32 v128, v96, v97
    v_cvt_pk_bf16_f32 v129, v98, v99
    v_cvt_pk_bf16_f32 v130, v100, v101
    v_cvt_pk_bf16_f32 v131, v102, v103
    v_cvt_pk_bf16_f32 v132, v104, v105
    v_cvt_pk_bf16_f32 v133, v106, v107
    v_cvt_pk_bf16_f32 v134, v108, v109
    v_cvt_pk_bf16_f32 v135, v110, v111
    v_cvt_pk_bf16_f32 v138, v124, v125
    v_cvt_pk_bf16_f32 v139, v126, v127
    s_nop 0
    v_mfma_f32_32x32x16_bf16 v[208:223], v[232:235], v[128:131], 0
    v_mfma_f32_32x32x16_bf16 v[208:223], v[236:239], v[132:135], v[208:223]
    v_mfma_f32_32x32x16_bf16 v[208:223], v[248:251], v[136:139], v[208:223]
    v_mfma_f32_32x32x16_bf16 v[96:111], v[176:179], v[0:3], 0
    v_mfma_f32_32x32x16_bf16 v[96:111], v[180:183], v[4:7], v[96:111]
    s_nop 7
    s_nop 1
    v_mov_b32 v242, v220
    v_mov_b32 v243, v220
    s_nop 1
    v_permlane32_swap_b32 v242, v243
    s_nop 1
    v_rcp_f32 v243, v243
    s_nop 0
    v_mul_f32 v208, v208, v243
    v_mul_f32 v209, v209, v243
    v_mul_f32 v210, v210, v243
    v_mul_f32 v211, v211, v243
    v_mul_f32 v212, v212, v243
    v_mul_f32 v213, v213, v243
    v_mul_f32 v214, v214, v243
    v_mul_f32 v215, v215, v243
    v_mul_f32 v216, v216, v243
    v_mul_f32 v217, v217, v243
    v_mul_f32 v218, v218, v243
    v_mul_f32 v219, v219, v243
    v_mul_f32 v220, v220, v243
    v_mul_f32 v221, v221, v243
    v_mul_f32 v222, v222, v243
    v_mul_f32 v223, v223, v243
    v_cvt_pk_bf16_f32 v224, v208, v209
    v_cvt_pk_bf16_f32 v225, v210, v211
    v_cvt_pk_bf16_f32 v226, v212, v213
    v_cvt_pk_bf16_f32 v227, v214, v215
    v_cvt_pk_bf16_f32 v228, v216, v217
    v_cvt_pk_bf16_f32 v229, v218, v219
    v_cvt_pk_bf16_f32 v230, v220, v221
    v_cvt_pk_bf16_f32 v231, v222, v223
    s_mov_b32 exec_lo, 0
    v_mov_b32 v230, 0
    v_mov_b32 v231, 0
    s_mov_b32 exec_lo, -1
    buffer_store_dwordx4 v[224:227], v240, s[8:11], s21 offen sc0 sc1
    buffer_store_dwordx4 v[228:231], v240, s[8:11], s21 offen offset:1024 sc0 sc1
    s_add_u32 s40, s16, 28672
    s_add_u32 s41, s17, 28672
    s_mul_i32 s34, s56, 96
    s_add_u32 s34, s34, 114688
    v_add_u32 v248, s34, v240
    s_mul_i32 s34, s57, 96
    s_add_u32 s34, s34, 114688
    v_add_u32 v249, s34, v240
    s_mul_i32 s34, s58, 96
    s_add_u32 s34, s34, 114688
    v_add_u32 v250, s34, v240
    s_mul_i32 s34, s59, 96
    s_add_u32 s34, s34, 114688
    v_add_u32 v251, s34, v240
    v_mfma_f32_32x32x16_bf16 v[112:127], v[176:179], v[8:11], 0
    v_exp_f32 v96, v96
    v_exp_f32 v97, v97
    v_exp_f32 v98, v98
    v_exp_f32 v99, v99
    v_cvt_pk_bf16_f32 v128, v96, v97
    v_cvt_pk_bf16_f32 v129, v98, v99
    v_mfma_f32_32x32x16_bf16 v[112:127], v[180:183], v[12:15], v[112:127]
    s_add_u32 s55, s16, 20480
    v_exp_f32 v100, v100
    v_exp_f32 v101, v101
    v_exp_f32 v102, v102
    v_exp_f32 v103, v103
    v_cvt_pk_bf16_f32 v130, v100, v101
    v_cvt_pk_bf16_f32 v131, v102, v103
    v_exp_f32 v104, v104
    v_exp_f32 v105, v105
    v_exp_f32 v106, v106
    v_exp_f32 v107, v107
    v_cvt_pk_bf16_f32 v132, v104, v105
    v_cvt_pk_bf16_f32 v133, v106, v107
    v_exp_f32 v108, v108
    v_exp_f32 v109, v109
    v_exp_f32 v110, v110
    v_exp_f32 v111, v111
    v_cvt_pk_bf16_f32 v134, v108, v109
    v_cvt_pk_bf16_f32 v135, v110, v111
    v_mfma_f32_32x32x16_bf16 v[96:111], v[176:179], v[16:19], 0
    v_exp_f32 v112, v112
    v_exp_f32 v113, v113
    v_exp_f32 v114, v114
    v_exp_f32 v115, v115
    v_cvt_pk_bf16_f32 v136, v112, v113
    v_cvt_pk_bf16_f32 v137, v114, v115
    v_mfma_f32_32x32x16_bf16 v[96:111], v[180:183], v[20:23], v[96:111]
    s_waitcnt vmcnt(12)
    v_exp_f32 v116, v116
    v_exp_f32 v117, v117
    v_exp_f32 v118, v118
    v_exp_f32 v119, v119
    v_cvt_pk_bf16_f32 v138, v116, v117
    v_cvt_pk_bf16_f32 v139, v118, v119
    v_mfma_f32_32x32x16_bf16 v[32:47], v[184:187], v[128:131], v[32:47]
    buffer_load_dwordx4 v[168:171], v240, s[8:11], s20 offen offset:2048
    v_exp_f32 v120, v120
    v_exp_f32 v121, v121
    v_exp_f32 v122, v122
    v_exp_f32 v123, v123
    v_cvt_pk_bf16_f32 v140, v120, v121
    v_cvt_pk_bf16_f32 v141, v122, v123
    v_mfma_f32_32x32x16_bf16 v[32:47], v[188:191], v[132:135], v[32:47]
    buffer_load_dwordx4 v[172:175], v240, s[8:11], s20 offen offset:3072
    v_exp_f32 v124, v124
    v_exp_f32 v125, v125
    v_exp_f32 v126, v126
    v_exp_f32 v127, v127
    v_cvt_pk_bf16_f32 v142, v124, v125
    v_cvt_pk_bf16_f32 v143, v126, v127
    v_mfma_f32_32x32x16_bf16 v[112:127], v[176:179], v[24:27], 0
    buffer_load_dwordx4 v[232:235], v240, s[8:11], s40 offen
    v_exp_f32 v96, v96
    v_exp_f32 v97, v97
    v_exp_f32 v98, v98
    v_exp_f32 v99, v99
    v_cvt_pk_bf16_f32 v128, v96, v97
    v_cvt_pk_bf16_f32 v129, v98, v99
    v_mfma_f32_32x32x16_bf16 v[112:127], v[180:183], v[28:31], v[112:127]
    buffer_load_dwordx4 v[236:239], v240, s[8:11], s40 offen offset:1024
    v_exp_f32 v100, v100
    v_exp_f32 v101, v101
    v_exp_f32 v102, v102
    v_exp_f32 v103, v103
    v_cvt_pk_bf16_f32 v130, v100, v101
    v_cvt_pk_bf16_f32 v131, v102, v103
    v_mfma_f32_32x32x16_bf16 v[48:63], v[184:187], v[136:139], v[48:63]
    buffer_load_dwordx4 v[208:211], v240, s[8:11], s40 offen offset:2048
    v_exp_f32 v104, v104
    v_exp_f32 v105, v105
    v_exp_f32 v106, v106
    v_exp_f32 v107, v107
    v_cvt_pk_bf16_f32 v132, v104, v105
    v_cvt_pk_bf16_f32 v133, v106, v107
    v_mfma_f32_32x32x16_bf16 v[48:63], v[188:191], v[140:143], v[48:63]
    s_waitcnt vmcnt(15)
    v_exp_f32 v108, v108
    v_exp_f32 v109, v109
    v_exp_f32 v110, v110
    v_exp_f32 v111, v111
    v_cvt_pk_bf16_f32 v134, v108, v109
    v_cvt_pk_bf16_f32 v135, v110, v111
    v_mfma_f32_32x32x16_bf16 v[96:111], v[192:195], v[0:3], 0
    buffer_load_dwordx4 v[176:179], v240, s[8:11], s55 offen
    v_exp_f32 v112, v112
    v_exp_f32 v113, v113
    v_exp_f32 v114, v114
    v_exp_f32 v115, v115
    v_cvt_pk_bf16_f32 v136, v112, v113
    v_cvt_pk_bf16_f32 v137, v114, v115
    v_mfma_f32_32x32x16_bf16 v[96:111], v[196:199], v[4:7], v[96:111]
    buffer_load_dwordx4 v[180:183], v240, s[8:11], s55 offen offset:1024
    v_exp_f32 v116, v116
    v_exp_f32 v117, v117
    v_exp_f32 v118, v118
    v_exp_f32 v119, v119
    v_cvt_pk_bf16_f32 v138, v116, v117
    v_cvt_pk_bf16_f32 v139, v118, v119
    v_mfma_f32_32x32x16_bf16 v[64:79], v[184:187], v[128:131], v[64:79]
    v_exp_f32 v120, v120
    v_exp_f32 v121, v121
    v_exp_f32 v122, v122
    v_exp_f32 v123, v123
    v_cvt_pk_bf16_f32 v140, v120, v121
    v_cvt_pk_bf16_f32 v141, v122, v123
    v_mfma_f32_32x32x16_bf16 v[64:79], v[188:191], v[132:135], v[64:79]
    v_exp_f32 v124, v124
    v_exp_f32 v125, v125
    v_exp_f32 v126, v126
    v_exp_f32 v127, v127
    v_cvt_pk_bf16_f32 v142, v124, v125
    v_cvt_pk_bf16_f32 v143, v126, v127
    v_mfma_f32_32x32x16_bf16 v[112:127], v[192:195], v[8:11], 0
    s_add_u32 s20, s17, 20480
    v_exp_f32 v96, v96
    v_exp_f32 v97, v97
    v_exp_f32 v98, v98
    v_exp_f32 v99, v99
    v_cvt_pk_bf16_f32 v128, v96, v97
    v_cvt_pk_bf16_f32 v129, v98, v99
    v_mfma_f32_32x32x16_bf16 v[112:127], v[196:199], v[12:15], v[112:127]
    v_exp_f32 v100, v100
    v_exp_f32 v101, v101
    v_exp_f32 v102, v102
    v_exp_f32 v103, v103
    v_cvt_pk_bf16_f32 v130, v100, v101
    v_cvt_pk_bf16_f32 v131, v102, v103
    v_mfma_f32_32x32x16_bf16 v[80:95], v[184:187], v[136:139], v[80:95]
    v_exp_f32 v104, v104
    v_exp_f32 v105, v105
    v_exp_f32 v106, v106
    v_exp_f32 v107, v107
    v_cvt_pk_bf16_f32 v132, v104, v105
    v_cvt_pk_bf16_f32 v133, v106, v107
    v_mfma_f32_32x32x16_bf16 v[80:95], v[188:191], v[140:143], v[80:95]
    v_exp_f32 v108, v108
    v_exp_f32 v109, v109
    v_exp_f32 v110, v110
    v_exp_f32 v111, v111
    v_cvt_pk_bf16_f32 v134, v108, v109
    v_cvt_pk_bf16_f32 v135, v110, v111
    v_mfma_f32_32x32x16_bf16 v[96:111], v[192:195], v[16:19], 0
    v_exp_f32 v112, v112
    v_exp_f32 v113, v113
    v_exp_f32 v114, v114
    v_exp_f32 v115, v115
    v_cvt_pk_bf16_f32 v136, v112, v113
    v_cvt_pk_bf16_f32 v137, v114, v115
    v_mfma_f32_32x32x16_bf16 v[96:111], v[196:199], v[20:23], v[96:111]
    s_waitcnt vmcnt(15)
    v_exp_f32 v116, v116
    v_exp_f32 v117, v117
    v_exp_f32 v118, v118
    v_exp_f32 v119, v119
    v_cvt_pk_bf16_f32 v138, v116, v117
    v_cvt_pk_bf16_f32 v139, v118, v119
    v_mfma_f32_32x32x16_bf16 v[32:47], v[200:203], v[128:131], v[32:47]
    buffer_load_dwordx4 v[184:187], v240, s[8:11], s20 offen
    v_exp_f32 v120, v120
    v_exp_f32 v121, v121
    v_exp_f32 v122, v122
    v_exp_f32 v123, v123
    v_cvt_pk_bf16_f32 v140, v120, v121
    v_cvt_pk_bf16_f32 v141, v122, v123
    v_mfma_f32_32x32x16_bf16 v[32:47], v[204:207], v[132:135], v[32:47]
    buffer_load_dwordx4 v[188:191], v240, s[8:11], s20 offen offset:1024
    v_exp_f32 v124, v124
    v_exp_f32 v125, v125
    v_exp_f32 v126, v126
    v_exp_f32 v127, v127
    v_cvt_pk_bf16_f32 v142, v124, v125
    v_cvt_pk_bf16_f32 v143, v126, v127
    v_mfma_f32_32x32x16_bf16 v[112:127], v[192:195], v[24:27], 0
    buffer_load_dwordx4 v[212:215], v240, s[8:11], s40 offen offset:3072
    v_exp_f32 v96, v96
    v_exp_f32 v97, v97
    v_exp_f32 v98, v98
    v_exp_f32 v99, v99
    v_cvt_pk_bf16_f32 v128, v96, v97
    v_cvt_pk_bf16_f32 v129, v98, v99
    v_mfma_f32_32x32x16_bf16 v[112:127], v[196:199], v[28:31], v[112:127]
    buffer_load_dwordx4 v[216:219], v240, s[8:11], s41 offen offset:2048
    v_exp_f32 v100, v100
    v_exp_f32 v101, v101
    v_exp_f32 v102, v102
    v_exp_f32 v103, v103
    v_cvt_pk_bf16_f32 v130, v100, v101
    v_cvt_pk_bf16_f32 v131, v102, v103
    v_mfma_f32_32x32x16_bf16 v[48:63], v[200:203], v[136:139], v[48:63]
    buffer_load_dwordx4 v[220:223], v240, s[8:11], s41 offen offset:3072
    v_exp_f32 v104, v104
    v_exp_f32 v105, v105
    v_exp_f32 v106, v106
    v_exp_f32 v107, v107
    v_cvt_pk_bf16_f32 v132, v104, v105
    v_cvt_pk_bf16_f32 v133, v106, v107
    v_mfma_f32_32x32x16_bf16 v[48:63], v[204:207], v[140:143], v[48:63]
    s_waitcnt vmcnt(18)
    v_exp_f32 v108, v108
    v_exp_f32 v109, v109
    v_exp_f32 v110, v110
    v_exp_f32 v111, v111
    v_cvt_pk_bf16_f32 v134, v108, v109
    v_cvt_pk_bf16_f32 v135, v110, v111
    v_mfma_f32_32x32x16_bf16 v[96:111], v[144:147], v[0:3], 0
    buffer_load_dwordx4 v[192:195], v240, s[8:11], s55 offen offset:2048
    v_exp_f32 v112, v112
    v_exp_f32 v113, v113
    v_exp_f32 v114, v114
    v_exp_f32 v115, v115
    v_cvt_pk_bf16_f32 v136, v112, v113
    v_cvt_pk_bf16_f32 v137, v114, v115
    v_mfma_f32_32x32x16_bf16 v[96:111], v[148:151], v[4:7], v[96:111]
    buffer_load_dwordx4 v[196:199], v240, s[8:11], s55 offen offset:3072
    v_exp_f32 v116, v116
    v_exp_f32 v117, v117
    v_exp_f32 v118, v118
    v_exp_f32 v119, v119
    v_cvt_pk_bf16_f32 v138, v116, v117
    v_cvt_pk_bf16_f32 v139, v118, v119
    v_mfma_f32_32x32x16_bf16 v[64:79], v[200:203], v[128:131], v[64:79]
    v_exp_f32 v120, v120
    v_exp_f32 v121, v121
    v_exp_f32 v122, v122
    v_exp_f32 v123, v123
    v_cvt_pk_bf16_f32 v140, v120, v121
    v_cvt_pk_bf16_f32 v141, v122, v123
    v_mfma_f32_32x32x16_bf16 v[64:79], v[204:207], v[132:135], v[64:79]
    v_exp_f32 v124, v124
    v_exp_f32 v125, v125
    v_exp_f32 v126, v126
    v_exp_f32 v127, v127
    v_cvt_pk_bf16_f32 v142, v124, v125
    v_cvt_pk_bf16_f32 v143, v126, v127
    v_mfma_f32_32x32x16_bf16 v[112:127], v[144:147], v[8:11], 0
    v_exp_f32 v96, v96
    v_exp_f32 v97, v97
    v_exp_f32 v98, v98
    v_exp_f32 v99, v99
    v_cvt_pk_bf16_f32 v128, v96, v97
    v_cvt_pk_bf16_f32 v129, v98, v99
    v_mfma_f32_32x32x16_bf16 v[112:127], v[148:151], v[12:15], v[112:127]
    s_add_u32 s55, s16, 24576
    v_exp_f32 v100, v100
    v_exp_f32 v101, v101
    v_exp_f32 v102, v102
    v_exp_f32 v103, v103
    v_cvt_pk_bf16_f32 v130, v100, v101
    v_cvt_pk_bf16_f32 v131, v102, v103
    v_mfma_f32_32x32x16_bf16 v[80:95], v[200:203], v[136:139], v[80:95]
    v_exp_f32 v104, v104
    v_exp_f32 v105, v105
    v_exp_f32 v106, v106
    v_exp_f32 v107, v107
    v_cvt_pk_bf16_f32 v132, v104, v105
    v_cvt_pk_bf16_f32 v133, v106, v107
    v_mfma_f32_32x32x16_bf16 v[80:95], v[204:207], v[140:143], v[80:95]
    v_exp_f32 v108, v108
    v_exp_f32 v109, v109
    v_exp_f32 v110, v110
    v_exp_f32 v111, v111
    v_cvt_pk_bf16_f32 v134, v108, v109
    v_cvt_pk_bf16_f32 v135, v110, v111
    v_mfma_f32_32x32x16_bf16 v[96:111], v[144:147], v[16:19], 0
    v_exp_f32 v112, v112
    v_exp_f32 v113, v113
    v_exp_f32 v114, v114
    v_exp_f32 v115, v115
    v_cvt_pk_bf16_f32 v136, v112, v113
    v_cvt_pk_bf16_f32 v137, v114, v115
    v_mfma_f32_32x32x16_bf16 v[96:111], v[148:151], v[20:23], v[96:111]
    s_waitcnt vmcnt(18)
    v_exp_f32 v116, v116
    v_exp_f32 v117, v117
    v_exp_f32 v118, v118
    v_exp_f32 v119, v119
    v_cvt_pk_bf16_f32 v138, v116, v117
    v_cvt_pk_bf16_f32 v139, v118, v119
    v_mfma_f32_32x32x16_bf16 v[32:47], v[152:155], v[128:131], v[32:47]
    buffer_load_dwordx4 v[200:203], v240, s[8:11], s20 offen offset:2048
    v_exp_f32 v120, v120
    v_exp_f32 v121, v121
    v_exp_f32 v122, v122
    v_exp_f32 v123, v123
    v_cvt_pk_bf16_f32 v140, v120, v121
    v_cvt_pk_bf16_f32 v141, v122, v123
    v_mfma_f32_32x32x16_bf16 v[32:47], v[156:159], v[132:135], v[32:47]
    buffer_load_dwordx4 v[204:207], v240, s[8:11], s20 offen offset:3072
    v_exp_f32 v124, v124
    v_exp_f32 v125, v125
    v_exp_f32 v126, v126
    v_exp_f32 v127, v127
    v_cvt_pk_bf16_f32 v142, v124, v125
    v_cvt_pk_bf16_f32 v143, v126, v127
    v_mfma_f32_32x32x16_bf16 v[112:127], v[144:147], v[24:27], 0
    v_exp_f32 v96, v96
    v_exp_f32 v97, v97
    v_exp_f32 v98, v98
    v_exp_f32 v99, v99
    v_cvt_pk_bf16_f32 v128, v96, v97
    v_cvt_pk_bf16_f32 v129, v98, v99
    v_mfma_f32_32x32x16_bf16 v[112:127], v[148:151], v[28:31], v[112:127]
    v_exp_f32 v100, v100
    v_exp_f32 v101, v101
    v_exp_f32 v102, v102
    v_exp_f32 v103, v103
    v_cvt_pk_bf16_f32 v130, v100, v101
    v_cvt_pk_bf16_f32 v131, v102, v103
    v_mfma_f32_32x32x16_bf16 v[48:63], v[152:155], v[136:139], v[48:63]
    v_exp_f32 v104, v104
    v_exp_f32 v105, v105
    v_exp_f32 v106, v106
    v_exp_f32 v107, v107
    v_cvt_pk_bf16_f32 v132, v104, v105
    v_cvt_pk_bf16_f32 v133, v106, v107
    v_mfma_f32_32x32x16_bf16 v[48:63], v[156:159], v[140:143], v[48:63]
    s_waitcnt vmcnt(18)
    v_exp_f32 v108, v108
    v_exp_f32 v109, v109
    v_exp_f32 v110, v110
    v_exp_f32 v111, v111
    v_cvt_pk_bf16_f32 v134, v108, v109
    v_cvt_pk_bf16_f32 v135, v110, v111
    v_mfma_f32_32x32x16_bf16 v[96:111], v[160:163], v[0:3], 0
    buffer_load_dwordx4 v[144:147], v240, s[8:11], s55 offen
    v_exp_f32 v112, v112
    v_exp_f32 v113, v113
    v_exp_f32 v114, v114
    v_exp_f32 v115, v115
    v_cvt_pk_bf16_f32 v136, v112, v113
    v_cvt_pk_bf16_f32 v137, v114, v115
    v_mfma_f32_32x32x16_bf16 v[96:111], v[164:167], v[4:7], v[96:111]
    buffer_load_dwordx4 v[148:151], v240, s[8:11], s55 offen offset:1024
    v_exp_f32 v116, v116
    v_exp_f32 v117, v117
    v_exp_f32 v118, v118
    v_exp_f32 v119, v119
    v_cvt_pk_bf16_f32 v138, v116, v117
    v_cvt_pk_bf16_f32 v139, v118, v119
    v_mfma_f32_32x32x16_bf16 v[64:79], v[152:155], v[128:131], v[64:79]
    v_exp_f32 v120, v120
    v_exp_f32 v121, v121
    v_exp_f32 v122, v122
    v_exp_f32 v123, v123
    v_cvt_pk_bf16_f32 v140, v120, v121
    v_cvt_pk_bf16_f32 v141, v122, v123
    v_mfma_f32_32x32x16_bf16 v[64:79], v[156:159], v[132:135], v[64:79]
    v_exp_f32 v124, v124
    v_exp_f32 v125, v125
    v_exp_f32 v126, v126
    v_exp_f32 v127, v127
    v_cvt_pk_bf16_f32 v142, v124, v125
    v_cvt_pk_bf16_f32 v143, v126, v127
    v_mfma_f32_32x32x16_bf16 v[112:127], v[160:163], v[8:11], 0
    s_add_u32 s20, s17, 24576
    v_exp_f32 v96, v96
    v_exp_f32 v97, v97
    v_exp_f32 v98, v98
    v_exp_f32 v99, v99
    v_cvt_pk_bf16_f32 v128, v96, v97
    v_cvt_pk_bf16_f32 v129, v98, v99
    v_mfma_f32_32x32x16_bf16 v[112:127], v[164:167], v[12:15], v[112:127]
    v_exp_f32 v100, v100
    v_exp_f32 v101, v101
    v_exp_f32 v102, v102
    v_exp_f32 v103, v103
    v_cvt_pk_bf16_f32 v130, v100, v101
    v_cvt_pk_bf16_f32 v131, v102, v103
    v_mfma_f32_32x32x16_bf16 v[80:95], v[152:155], v[136:139], v[80:95]
    v_exp_f32 v104, v104
    v_exp_f32 v105, v105
    v_exp_f32 v106, v106
    v_exp_f32 v107, v107
    v_cvt_pk_bf16_f32 v132, v104, v105
    v_cvt_pk_bf16_f32 v133, v106, v107
    v_mfma_f32_32x32x16_bf16 v[80:95], v[156:159], v[140:143], v[80:95]
    v_exp_f32 v108, v108
    v_exp_f32 v109, v109
    v_exp_f32 v110, v110
    v_exp_f32 v111, v111
    v_cvt_pk_bf16_f32 v134, v108, v109
    v_cvt_pk_bf16_f32 v135, v110, v111
    v_mfma_f32_32x32x16_bf16 v[96:111], v[160:163], v[16:19], 0
    v_exp_f32 v112, v112
    v_exp_f32 v113, v113
    v_exp_f32 v114, v114
    v_exp_f32 v115, v115
    v_cvt_pk_bf16_f32 v136, v112, v113
    v_cvt_pk_bf16_f32 v137, v114, v115
    v_mfma_f32_32x32x16_bf16 v[96:111], v[164:167], v[20:23], v[96:111]
    s_waitcnt vmcnt(16)
    v_exp_f32 v116, v116
    v_exp_f32 v117, v117
    v_exp_f32 v118, v118
    v_exp_f32 v119, v119
    v_cvt_pk_bf16_f32 v138, v116, v117
    v_cvt_pk_bf16_f32 v139, v118, v119
    v_mfma_f32_32x32x16_bf16 v[32:47], v[168:171], v[128:131], v[32:47]
    buffer_load_dwordx4 v[152:155], v240, s[8:11], s20 offen
    v_exp_f32 v120, v120
    v_exp_f32 v121, v121
    v_exp_f32 v122, v122
    v_exp_f32 v123, v123
    v_cvt_pk_bf16_f32 v140, v120, v121
    v_cvt_pk_bf16_f32 v141, v122, v123
    v_mfma_f32_32x32x16_bf16 v[32:47], v[172:175], v[132:135], v[32:47]
    buffer_load_dwordx4 v[156:159], v240, s[8:11], s20 offen offset:1024
    v_exp_f32 v124, v124
    v_exp_f32 v125, v125
    v_exp_f32 v126, v126
    v_exp_f32 v127, v127
    v_cvt_pk_bf16_f32 v142, v124, v125
    v_cvt_pk_bf16_f32 v143, v126, v127
    v_mfma_f32_32x32x16_bf16 v[112:127], v[160:163], v[24:27], 0
    buffer_load_dwordx4 v[224:227], v240, s[8:11], s41 offen
    v_exp_f32 v96, v96
    v_exp_f32 v97, v97
    v_exp_f32 v98, v98
    v_exp_f32 v99, v99
    v_cvt_pk_bf16_f32 v128, v96, v97
    v_cvt_pk_bf16_f32 v129, v98, v99
    v_mfma_f32_32x32x16_bf16 v[112:127], v[164:167], v[28:31], v[112:127]
    buffer_load_dwordx4 v[228:231], v240, s[8:11], s41 offen offset:1024
    v_exp_f32 v100, v100
    v_exp_f32 v101, v101
    v_exp_f32 v102, v102
    v_exp_f32 v103, v103
    v_cvt_pk_bf16_f32 v130, v100, v101
    v_cvt_pk_bf16_f32 v131, v102, v103
    v_mfma_f32_32x32x16_bf16 v[48:63], v[168:171], v[136:139], v[48:63]
    v_exp_f32 v104, v104
    v_exp_f32 v105, v105
    v_exp_f32 v106, v106
    v_exp_f32 v107, v107
    v_cvt_pk_bf16_f32 v132, v104, v105
    v_cvt_pk_bf16_f32 v133, v106, v107
    v_mfma_f32_32x32x16_bf16 v[48:63], v[172:175], v[140:143], v[48:63]
    s_waitcnt vmcnt(15)
    v_exp_f32 v108, v108
    v_exp_f32 v109, v109
    v_exp_f32 v110, v110
    v_exp_f32 v111, v111
    v_cvt_pk_bf16_f32 v134, v108, v109
    v_cvt_pk_bf16_f32 v135, v110, v111
    v_mfma_f32_32x32x16_bf16 v[96:111], v[176:179], v[0:3], 0
    buffer_load_dwordx4 v[160:163], v240, s[8:11], s55 offen offset:2048
    v_exp_f32 v112, v112
    v_exp_f32 v113, v113
    v_exp_f32 v114, v114
    v_exp_f32 v115, v115
    v_cvt_pk_bf16_f32 v136, v112, v113
    v_cvt_pk_bf16_f32 v137, v114, v115
    v_mfma_f32_32x32x16_bf16 v[96:111], v[180:183], v[4:7], v[96:111]
    buffer_load_dwordx4 v[164:167], v240, s[8:11], s55 offen offset:3072
    v_exp_f32 v116, v116
    v_exp_f32 v117, v117
    v_exp_f32 v118, v118
    v_exp_f32 v119, v119
    v_cvt_pk_bf16_f32 v138, v116, v117
    v_cvt_pk_bf16_f32 v139, v118, v119
    v_mfma_f32_32x32x16_bf16 v[64:79], v[168:171], v[128:131], v[64:79]
    buffer_store_dword v247, v246, s[8:11], s22 offen sc0 sc1
    v_exp_f32 v120, v120
    v_exp_f32 v121, v121
    v_exp_f32 v122, v122
    v_exp_f32 v123, v123
    v_cvt_pk_bf16_f32 v140, v120, v121
    v_cvt_pk_bf16_f32 v141, v122, v123
    v_mfma_f32_32x32x16_bf16 v[64:79], v[172:175], v[132:135], v[64:79]
    v_exp_f32 v124, v124
    v_exp_f32 v125, v125
    v_exp_f32 v126, v126
    v_exp_f32 v127, v127
    v_cvt_pk_bf16_f32 v142, v124, v125
    v_cvt_pk_bf16_f32 v143, v126, v127
    v_mfma_f32_32x32x16_bf16 v[112:127], v[176:179], v[8:11], 0
    v_exp_f32 v96, v96
    v_exp_f32 v97, v97
    v_exp_f32 v98, v98
    v_exp_f32 v99, v99
    v_cvt_pk_bf16_f32 v128, v96, v97
    v_cvt_pk_bf16_f32 v129, v98, v99
    v_mfma_f32_32x32x16_bf16 v[112:127], v[180:183], v[12:15], v[112:127]
    v_exp_f32 v100, v100
    v_exp_f32 v101, v101
    v_exp_f32 v102, v102
    v_exp_f32 v103, v103
    v_cvt_pk_bf16_f32 v130, v100, v101
    v_cvt_pk_bf16_f32 v131, v102, v103
    v_mfma_f32_32x32x16_bf16 v[80:95], v[168:171], v[136:139], v[80:95]
    v_exp_f32 v104, v104
    v_exp_f32 v105, v105
    v_exp_f32 v106, v106
    v_exp_f32 v107, v107
    v_cvt_pk_bf16_f32 v132, v104, v105
    v_cvt_pk_bf16_f32 v133, v106, v107
    v_mfma_f32_32x32x16_bf16 v[80:95], v[172:175], v[140:143], v[80:95]
    v_exp_f32 v108, v108
    v_exp_f32 v109, v109
    v_exp_f32 v110, v110
    v_exp_f32 v111, v111
    v_cvt_pk_bf16_f32 v134, v108, v109
    v_cvt_pk_bf16_f32 v135, v110, v111
    v_mfma_f32_32x32x16_bf16 v[96:111], v[176:179], v[16:19], 0
    v_exp_f32 v112, v112
    v_exp_f32 v113, v113
    v_exp_f32 v114, v114
    v_exp_f32 v115, v115
    v_cvt_pk_bf16_f32 v136, v112, v113
    v_cvt_pk_bf16_f32 v137, v114, v115
    v_mfma_f32_32x32x16_bf16 v[96:111], v[180:183], v[20:23], v[96:111]
    s_waitcnt vmcnt(16)
    v_exp_f32 v116, v116
    v_exp_f32 v117, v117
    v_exp_f32 v118, v118
    v_exp_f32 v119, v119
    v_cvt_pk_bf16_f32 v138, v116, v117
    v_cvt_pk_bf16_f32 v139, v118, v119
    v_mfma_f32_32x32x16_bf16 v[32:47], v[184:187], v[128:131], v[32:47]
    buffer_load_dwordx4 v[168:171], v240, s[8:11], s20 offen offset:2048
    v_exp_f32 v120, v120
    v_exp_f32 v121, v121
    v_exp_f32 v122, v122
    v_exp_f32 v123, v123
    v_cvt_pk_bf16_f32 v140, v120, v121
    v_cvt_pk_bf16_f32 v141, v122, v123
    v_mfma_f32_32x32x16_bf16 v[32:47], v[188:191], v[132:135], v[32:47]
    buffer_load_dwordx4 v[172:175], v240, s[8:11], s20 offen offset:3072
    v_exp_f32 v124, v124
    v_exp_f32 v125, v125
    v_exp_f32 v126, v126
    v_exp_f32 v127, v127
    v_cvt_pk_bf16_f32 v142, v124, v125
    v_cvt_pk_bf16_f32 v143, v126, v127
    v_mfma_f32_32x32x16_bf16 v[112:127], v[176:179], v[24:27], 0
    s_barrier
    v_exp_f32 v96, v96
    v_exp_f32 v97, v97
    v_exp_f32 v98, v98
    v_exp_f32 v99, v99
    v_cvt_pk_bf16_f32 v128, v96, v97
    v_cvt_pk_bf16_f32 v129, v98, v99
    v_mfma_f32_32x32x16_bf16 v[112:127], v[180:183], v[28:31], v[112:127]
    v_exp_f32 v100, v100
    v_exp_f32 v101, v101
    v_exp_f32 v102, v102
    v_exp_f32 v103, v103
    v_cvt_pk_bf16_f32 v130, v100, v101
    v_cvt_pk_bf16_f32 v131, v102, v103
    v_mfma_f32_32x32x16_bf16 v[48:63], v[184:187], v[136:139], v[48:63]
    v_exp_f32 v104, v104
    v_exp_f32 v105, v105
    v_exp_f32 v106, v106
    v_exp_f32 v107, v107
    v_cvt_pk_bf16_f32 v132, v104, v105
    v_cvt_pk_bf16_f32 v133, v106, v107
    v_mfma_f32_32x32x16_bf16 v[48:63], v[188:191], v[140:143], v[48:63]
    s_waitcnt vmcnt(13)
    v_exp_f32 v108, v108
    v_exp_f32 v109, v109
    v_exp_f32 v110, v110
    v_exp_f32 v111, v111
    v_cvt_pk_bf16_f32 v134, v108, v109
    v_cvt_pk_bf16_f32 v135, v110, v111
    v_mfma_f32_32x32x16_bf16 v[96:111], v[192:195], v[0:3], 0
    v_exp_f32 v112, v112
    v_exp_f32 v113, v113
    v_exp_f32 v114, v114
    v_exp_f32 v115, v115
    v_cvt_pk_bf16_f32 v136, v112, v113
    v_cvt_pk_bf16_f32 v137, v114, v115
    v_mfma_f32_32x32x16_bf16 v[96:111], v[196:199], v[4:7], v[96:111]
    v_exp_f32 v116, v116
    v_exp_f32 v117, v117
    v_exp_f32 v118, v118
    v_exp_f32 v119, v119
    v_cvt_pk_bf16_f32 v138, v116, v117
    v_cvt_pk_bf16_f32 v139, v118, v119
    v_mfma_f32_32x32x16_bf16 v[64:79], v[184:187], v[128:131], v[64:79]
    v_exp_f32 v120, v120
    v_exp_f32 v121, v121
    v_exp_f32 v122, v122
    v_exp_f32 v123, v123
    v_cvt_pk_bf16_f32 v140, v120, v121
    v_cvt_pk_bf16_f32 v141, v122, v123
    v_mfma_f32_32x32x16_bf16 v[64:79], v[188:191], v[132:135], v[64:79]
    v_exp_f32 v124, v124
    v_exp_f32 v125, v125
    v_exp_f32 v126, v126
    v_exp_f32 v127, v127
    v_cvt_pk_bf16_f32 v142, v124, v125
    v_cvt_pk_bf16_f32 v143, v126, v127
    v_mfma_f32_32x32x16_bf16 v[112:127], v[192:195], v[8:11], 0
    v_exp_f32 v96, v96
    v_exp_f32 v97, v97
    v_exp_f32 v98, v98
    v_exp_f32 v99, v99
    v_cvt_pk_bf16_f32 v128, v96, v97
    v_cvt_pk_bf16_f32 v129, v98, v99
    v_mfma_f32_32x32x16_bf16 v[112:127], v[196:199], v[12:15], v[112:127]
    v_exp_f32 v100, v100
    v_exp_f32 v101, v101
    v_exp_f32 v102, v102
    v_exp_f32 v103, v103
    v_cvt_pk_bf16_f32 v130, v100, v101
    v_cvt_pk_bf16_f32 v131, v102, v103
    v_mfma_f32_32x32x16_bf16 v[80:95], v[184:187], v[136:139], v[80:95]
    v_exp_f32 v104, v104
    v_exp_f32 v105, v105
    v_exp_f32 v106, v106
    v_exp_f32 v107, v107
    v_cvt_pk_bf16_f32 v132, v104, v105
    v_cvt_pk_bf16_f32 v133, v106, v107
    v_mfma_f32_32x32x16_bf16 v[80:95], v[188:191], v[140:143], v[80:95]
    v_exp_f32 v108, v108
    v_exp_f32 v109, v109
    v_exp_f32 v110, v110
    v_exp_f32 v111, v111
    v_cvt_pk_bf16_f32 v134, v108, v109
    v_cvt_pk_bf16_f32 v135, v110, v111
    v_mfma_f32_32x32x16_bf16 v[96:111], v[192:195], v[16:19], 0
    v_exp_f32 v112, v112
    v_exp_f32 v113, v113
    v_exp_f32 v114, v114
    v_exp_f32 v115, v115
    v_cvt_pk_bf16_f32 v136, v112, v113
    v_cvt_pk_bf16_f32 v137, v114, v115
    v_mfma_f32_32x32x16_bf16 v[96:111], v[196:199], v[20:23], v[96:111]
    s_waitcnt vmcnt(11)
    v_exp_f32 v116, v116
    v_exp_f32 v117, v117
    v_exp_f32 v118, v118
    v_exp_f32 v119, v119
    v_cvt_pk_bf16_f32 v138, v116, v117
    v_cvt_pk_bf16_f32 v139, v118, v119
    v_mfma_f32_32x32x16_bf16 v[32:47], v[200:203], v[128:131], v[32:47]
    v_exp_f32 v120, v120
    v_exp_f32 v121, v121
    v_exp_f32 v122, v122
    v_exp_f32 v123, v123
    v_cvt_pk_bf16_f32 v140, v120, v121
    v_cvt_pk_bf16_f32 v141, v122, v123
    v_mfma_f32_32x32x16_bf16 v[32:47], v[204:207], v[132:135], v[32:47]
    v_exp_f32 v124, v124
    v_exp_f32 v125, v125
    v_exp_f32 v126, v126
    v_exp_f32 v127, v127
    v_cvt_pk_bf16_f32 v142, v124, v125
    v_cvt_pk_bf16_f32 v143, v126, v127
    v_mfma_f32_32x32x16_bf16 v[112:127], v[192:195], v[24:27], 0
    v_exp_f32 v96, v96
    v_exp_f32 v97, v97
    v_exp_f32 v98, v98
    v_exp_f32 v99, v99
    v_cvt_pk_bf16_f32 v128, v96, v97
    v_cvt_pk_bf16_f32 v129, v98, v99
    v_mfma_f32_32x32x16_bf16 v[112:127], v[196:199], v[28:31], v[112:127]
    v_exp_f32 v100, v100
    v_exp_f32 v101, v101
    v_exp_f32 v102, v102
    v_exp_f32 v103, v103
    v_cvt_pk_bf16_f32 v130, v100, v101
    v_cvt_pk_bf16_f32 v131, v102, v103
    v_mfma_f32_32x32x16_bf16 v[48:63], v[200:203], v[136:139], v[48:63]
    v_exp_f32 v104, v104
    v_exp_f32 v105, v105
    v_exp_f32 v106, v106
    v_exp_f32 v107, v107
    v_cvt_pk_bf16_f32 v132, v104, v105
    v_cvt_pk_bf16_f32 v133, v106, v107
    v_mfma_f32_32x32x16_bf16 v[48:63], v[204:207], v[140:143], v[48:63]
    s_waitcnt vmcnt(9)
    v_exp_f32 v108, v108
    v_exp_f32 v109, v109
    v_exp_f32 v110, v110
    v_exp_f32 v111, v111
    v_cvt_pk_bf16_f32 v134, v108, v109
    v_cvt_pk_bf16_f32 v135, v110, v111
    v_mfma_f32_32x32x16_bf16 v[96:111], v[144:147], v[0:3], 0
    v_exp_f32 v112, v112
    v_exp_f32 v113, v113
    v_exp_f32 v114, v114
    v_exp_f32 v115, v115
    v_cvt_pk_bf16_f32 v136, v112, v113
    v_cvt_pk_bf16_f32 v137, v114, v115
    v_mfma_f32_32x32x16_bf16 v[96:111], v[148:151], v[4:7], v[96:111]
    v_exp_f32 v116, v116
    v_exp_f32 v117, v117
    v_exp_f32 v118, v118
    v_exp_f32 v119, v119
    v_cvt_pk_bf16_f32 v138, v116, v117
    v_cvt_pk_bf16_f32 v139, v118, v119
    v_mfma_f32_32x32x16_bf16 v[64:79], v[200:203], v[128:131], v[64:79]
    v_exp_f32 v120, v120
    v_exp_f32 v121, v121
    v_exp_f32 v122, v122
    v_exp_f32 v123, v123
    v_cvt_pk_bf16_f32 v140, v120, v121
    v_cvt_pk_bf16_f32 v141, v122, v123
    v_mfma_f32_32x32x16_bf16 v[64:79], v[204:207], v[132:135], v[64:79]
    v_exp_f32 v124, v124
    v_exp_f32 v125, v125
    v_exp_f32 v126, v126
    v_exp_f32 v127, v127
    v_cvt_pk_bf16_f32 v142, v124, v125
    v_cvt_pk_bf16_f32 v143, v126, v127
    v_mfma_f32_32x32x16_bf16 v[112:127], v[144:147], v[8:11], 0
    v_exp_f32 v96, v96
    v_exp_f32 v97, v97
    v_exp_f32 v98, v98
    v_exp_f32 v99, v99
    v_cvt_pk_bf16_f32 v128, v96, v97
    v_cvt_pk_bf16_f32 v129, v98, v99
    v_mfma_f32_32x32x16_bf16 v[112:127], v[148:151], v[12:15], v[112:127]
    v_exp_f32 v100, v100
    v_exp_f32 v101, v101
    v_exp_f32 v102, v102
    v_exp_f32 v103, v103
    v_cvt_pk_bf16_f32 v130, v100, v101
    v_cvt_pk_bf16_f32 v131, v102, v103
    v_mfma_f32_32x32x16_bf16 v[80:95], v[200:203], v[136:139], v[80:95]
    v_exp_f32 v104, v104
    v_exp_f32 v105, v105
    v_exp_f32 v106, v106
    v_exp_f32 v107, v107
    v_cvt_pk_bf16_f32 v132, v104, v105
    v_cvt_pk_bf16_f32 v133, v106, v107
    v_mfma_f32_32x32x16_bf16 v[80:95], v[204:207], v[140:143], v[80:95]
    v_exp_f32 v108, v108
    v_exp_f32 v109, v109
    v_exp_f32 v110, v110
    v_exp_f32 v111, v111
    v_cvt_pk_bf16_f32 v134, v108, v109
    v_cvt_pk_bf16_f32 v135, v110, v111
    v_mfma_f32_32x32x16_bf16 v[96:111], v[144:147], v[16:19], 0
    v_exp_f32 v112, v112
    v_exp_f32 v113, v113
    v_exp_f32 v114, v114
    v_exp_f32 v115, v115
    v_cvt_pk_bf16_f32 v136, v112, v113
    v_cvt_pk_bf16_f32 v137, v114, v115
    v_mfma_f32_32x32x16_bf16 v[96:111], v[148:151], v[20:23], v[96:111]
    s_waitcnt vmcnt(7)
    v_exp_f32 v116, v116
    v_exp_f32 v117, v117
    v_exp_f32 v118, v118
    v_exp_f32 v119, v119
    v_cvt_pk_bf16_f32 v138, v116, v117
    v_cvt_pk_bf16_f32 v139, v118, v119
    v_mfma_f32_32x32x16_bf16 v[32:47], v[152:155], v[128:131], v[32:47]
    v_exp_f32 v120, v120
    v_exp_f32 v121, v121
    v_exp_f32 v122, v122
    v_exp_f32 v123, v123
    v_cvt_pk_bf16_f32 v140, v120, v121
    v_cvt_pk_bf16_f32 v141, v122, v123
    v_mfma_f32_32x32x16_bf16 v[32:47], v[156:159], v[132:135], v[32:47]
    v_exp_f32 v124, v124
    v_exp_f32 v125, v125
    v_exp_f32 v126, v126
    v_exp_f32 v127, v127
    v_cvt_pk_bf16_f32 v142, v124, v125
    v_cvt_pk_bf16_f32 v143, v126, v127
    v_mfma_f32_32x32x16_bf16 v[112:127], v[144:147], v[24:27], 0
    v_exp_f32 v96, v96
    v_exp_f32 v97, v97
    v_exp_f32 v98, v98
    v_exp_f32 v99, v99
    v_cvt_pk_bf16_f32 v128, v96, v97
    v_cvt_pk_bf16_f32 v129, v98, v99
    v_mfma_f32_32x32x16_bf16 v[112:127], v[148:151], v[28:31], v[112:127]
    v_exp_f32 v100, v100
    v_exp_f32 v101, v101
    v_exp_f32 v102, v102
    v_exp_f32 v103, v103
    v_cvt_pk_bf16_f32 v130, v100, v101
    v_cvt_pk_bf16_f32 v131, v102, v103
    v_mfma_f32_32x32x16_bf16 v[48:63], v[152:155], v[136:139], v[48:63]
    v_exp_f32 v104, v104
    v_exp_f32 v105, v105
    v_exp_f32 v106, v106
    v_exp_f32 v107, v107
    v_cvt_pk_bf16_f32 v132, v104, v105
    v_cvt_pk_bf16_f32 v133, v106, v107
    v_mfma_f32_32x32x16_bf16 v[48:63], v[156:159], v[140:143], v[48:63]
    s_waitcnt vmcnt(3)
    v_exp_f32 v108, v108
    v_exp_f32 v109, v109
    v_exp_f32 v110, v110
    v_exp_f32 v111, v111
    v_cvt_pk_bf16_f32 v134, v108, v109
    v_cvt_pk_bf16_f32 v135, v110, v111
    v_mfma_f32_32x32x16_bf16 v[96:111], v[160:163], v[0:3], 0
    v_exp_f32 v112, v112
    v_exp_f32 v113, v113
    v_exp_f32 v114, v114
    v_exp_f32 v115, v115
    v_cvt_pk_bf16_f32 v136, v112, v113
    v_cvt_pk_bf16_f32 v137, v114, v115
    v_mfma_f32_32x32x16_bf16 v[96:111], v[164:167], v[4:7], v[96:111]
    v_exp_f32 v116, v116
    v_exp_f32 v117, v117
    v_exp_f32 v118, v118
    v_exp_f32 v119, v119
    v_cvt_pk_bf16_f32 v138, v116, v117
    v_cvt_pk_bf16_f32 v139, v118, v119
    v_mfma_f32_32x32x16_bf16 v[64:79], v[152:155], v[128:131], v[64:79]
    v_exp_f32 v120, v120
    v_exp_f32 v121, v121
    v_exp_f32 v122, v122
    v_exp_f32 v123, v123
    v_cvt_pk_bf16_f32 v140, v120, v121
    v_cvt_pk_bf16_f32 v141, v122, v123
    v_mfma_f32_32x32x16_bf16 v[64:79], v[156:159], v[132:135], v[64:79]
    v_exp_f32 v124, v124
    v_exp_f32 v125, v125
    v_exp_f32 v126, v126
    v_exp_f32 v127, v127
    v_cvt_pk_bf16_f32 v142, v124, v125
    v_cvt_pk_bf16_f32 v143, v126, v127
    v_mfma_f32_32x32x16_bf16 v[112:127], v[160:163], v[8:11], 0
    v_exp_f32 v96, v96
    v_exp_f32 v97, v97
    v_exp_f32 v98, v98
    v_exp_f32 v99, v99
    v_cvt_pk_bf16_f32 v128, v96, v97
    v_cvt_pk_bf16_f32 v129, v98, v99
    v_mfma_f32_32x32x16_bf16 v[112:127], v[164:167], v[12:15], v[112:127]
    v_exp_f32 v100, v100
    v_exp_f32 v101, v101
    v_exp_f32 v102, v102
    v_exp_f32 v103, v103
    v_cvt_pk_bf16_f32 v130, v100, v101
    v_cvt_pk_bf16_f32 v131, v102, v103
    v_mfma_f32_32x32x16_bf16 v[80:95], v[152:155], v[136:139], v[80:95]
    v_exp_f32 v104, v104
    v_exp_f32 v105, v105
    v_exp_f32 v106, v106
    v_exp_f32 v107, v107
    v_cvt_pk_bf16_f32 v132, v104, v105
    v_cvt_pk_bf16_f32 v133, v106, v107
    v_mfma_f32_32x32x16_bf16 v[80:95], v[156:159], v[140:143], v[80:95]
    v_exp_f32 v108, v108
    v_exp_f32 v109, v109
    v_exp_f32 v110, v110
    v_exp_f32 v111, v111
    v_cvt_pk_bf16_f32 v134, v108, v109
    v_cvt_pk_bf16_f32 v135, v110, v111
    v_mfma_f32_32x32x16_bf16 v[96:111], v[160:163], v[16:19], 0
    v_exp_f32 v112, v112
    v_exp_f32 v113, v113
    v_exp_f32 v114, v114
    v_exp_f32 v115, v115
    v_cvt_pk_bf16_f32 v136, v112, v113
    v_cvt_pk_bf16_f32 v137, v114, v115
    v_mfma_f32_32x32x16_bf16 v[96:111], v[164:167], v[20:23], v[96:111]
    s_waitcnt vmcnt(0)
    v_exp_f32 v116, v116
    v_exp_f32 v117, v117
    v_exp_f32 v118, v118
    v_exp_f32 v119, v119
    v_cvt_pk_bf16_f32 v138, v116, v117
    v_cvt_pk_bf16_f32 v139, v118, v119
    v_mfma_f32_32x32x16_bf16 v[32:47], v[168:171], v[128:131], v[32:47]
    v_exp_f32 v120, v120
    v_exp_f32 v121, v121
    v_exp_f32 v122, v122
    v_exp_f32 v123, v123
    v_cvt_pk_bf16_f32 v140, v120, v121
    v_cvt_pk_bf16_f32 v141, v122, v123
    v_mfma_f32_32x32x16_bf16 v[32:47], v[172:175], v[132:135], v[32:47]
    v_exp_f32 v124, v124
    v_exp_f32 v125, v125
    v_exp_f32 v126, v126
    v_exp_f32 v127, v127
    v_cvt_pk_bf16_f32 v142, v124, v125
    v_cvt_pk_bf16_f32 v143, v126, v127
    v_mfma_f32_32x32x16_bf16 v[112:127], v[160:163], v[24:27], 0
    v_exp_f32 v96, v96
    v_exp_f32 v97, v97
    v_exp_f32 v98, v98
    v_exp_f32 v99, v99
    v_cvt_pk_bf16_f32 v128, v96, v97
    v_cvt_pk_bf16_f32 v129, v98, v99
    v_mfma_f32_32x32x16_bf16 v[112:127], v[164:167], v[28:31], v[112:127]
    v_exp_f32 v100, v100
    v_exp_f32 v101, v101
    v_exp_f32 v102, v102
    v_exp_f32 v103, v103
    v_cvt_pk_bf16_f32 v130, v100, v101
    v_cvt_pk_bf16_f32 v131, v102, v103
    v_mfma_f32_32x32x16_bf16 v[48:63], v[168:171], v[136:139], v[48:63]
    v_exp_f32 v104, v104
    v_exp_f32 v105, v105
    v_exp_f32 v106, v106
    v_exp_f32 v107, v107
    v_cvt_pk_bf16_f32 v132, v104, v105
    v_cvt_pk_bf16_f32 v133, v106, v107
    v_mfma_f32_32x32x16_bf16 v[48:63], v[172:175], v[140:143], v[48:63]
    v_exp_f32 v108, v108
    v_exp_f32 v109, v109
    v_exp_f32 v110, v110
    v_exp_f32 v111, v111
    v_cvt_pk_bf16_f32 v134, v108, v109
    v_cvt_pk_bf16_f32 v135, v110, v111
    v_mfma_f32_32x32x16_bf16 v[96:111], v[232:235], v[8:11], 0
    v_exp_f32 v112, v112
    v_exp_f32 v113, v113
    v_exp_f32 v114, v114
    v_exp_f32 v115, v115
    v_cvt_pk_bf16_f32 v136, v112, v113
    v_cvt_pk_bf16_f32 v137, v114, v115
    v_mfma_f32_32x32x16_bf16 v[96:111], v[236:239], v[12:15], v[96:111]
    v_exp_f32 v116, v116
    v_exp_f32 v117, v117
    v_exp_f32 v118, v118
    v_exp_f32 v119, v119
    v_cvt_pk_bf16_f32 v138, v116, v117
    v_cvt_pk_bf16_f32 v139, v118, v119
    v_mfma_f32_32x32x16_bf16 v[64:79], v[168:171], v[128:131], v[64:79]
    v_exp_f32 v120, v120
    v_exp_f32 v121, v121
    v_exp_f32 v122, v122
    v_exp_f32 v123, v123
    v_cvt_pk_bf16_f32 v140, v120, v121
    v_cvt_pk_bf16_f32 v141, v122, v123
    v_mfma_f32_32x32x16_bf16 v[64:79], v[172:175], v[132:135], v[64:79]
    v_exp_f32 v124, v124
    v_exp_f32 v125, v125
    v_exp_f32 v126, v126
    v_exp_f32 v127, v127
    v_cvt_pk_bf16_f32 v142, v124, v125
    v_cvt_pk_bf16_f32 v143, v126, v127
    v_mfma_f32_32x32x16_bf16 v[112:127], v[208:211], v[8:11], 0
    v_exp_f32 v96, v96
    v_exp_f32 v97, v97
    v_exp_f32 v98, v98
    v_exp_f32 v99, v99
    v_cvt_pk_bf16_f32 v128, v96, v97
    v_cvt_pk_bf16_f32 v129, v98, v99
    v_mfma_f32_32x32x16_bf16 v[112:127], v[212:215], v[12:15], v[112:127]
    v_exp_f32 v100, v100
    v_exp_f32 v101, v101
    v_exp_f32 v102, v102
    v_exp_f32 v103, v103
    v_cvt_pk_bf16_f32 v130, v100, v101
    v_cvt_pk_bf16_f32 v131, v102, v103
    v_mfma_f32_32x32x16_bf16 v[80:95], v[168:171], v[136:139], v[80:95]
    v_exp_f32 v104, v104
    v_exp_f32 v105, v105
    v_exp_f32 v106, v106
    v_exp_f32 v107, v107
    v_cvt_pk_bf16_f32 v132, v104, v105
    v_cvt_pk_bf16_f32 v133, v106, v107
    v_mfma_f32_32x32x16_bf16 v[80:95], v[172:175], v[140:143], v[80:95]
    v_exp_f32 v108, v108
    v_exp_f32 v109, v109
    v_exp_f32 v110, v110
    v_exp_f32 v111, v111
    v_cvt_pk_bf16_f32 v134, v108, v109
    v_cvt_pk_bf16_f32 v135, v110, v111
    v_mfma_f32_32x32x16_bf16 v[96:111], v[232:235], v[16:19], 0
    v_exp_f32 v112, v112
    v_exp_f32 v113, v113
    v_exp_f32 v114, v114
    v_exp_f32 v115, v115
    v_cvt_pk_bf16_f32 v136, v112, v113
    v_cvt_pk_bf16_f32 v137, v114, v115
    v_mfma_f32_32x32x16_bf16 v[96:111], v[236:239], v[20:23], v[96:111]
    v_exp_f32 v116, v116
    v_exp_f32 v117, v117
    v_exp_f32 v118, v118
    v_exp_f32 v119, v119
    v_cvt_pk_bf16_f32 v138, v116, v117
    v_cvt_pk_bf16_f32 v139, v118, v119
    v_mfma_f32_32x32x16_bf16 v[48:63], v[224:227], v[128:131], v[48:63]
    v_exp_f32 v120, v120
    v_exp_f32 v121, v121
    v_exp_f32 v122, v122
    v_exp_f32 v123, v123
    v_cvt_pk_bf16_f32 v140, v120, v121
    v_cvt_pk_bf16_f32 v141, v122, v123
    v_mfma_f32_32x32x16_bf16 v[48:63], v[228:231], v[132:135], v[48:63]
    v_exp_f32 v124, v124
    v_exp_f32 v125, v125
    v_exp_f32 v126, v126
    v_exp_f32 v127, v127
    v_cvt_pk_bf16_f32 v142, v124, v125
    v_cvt_pk_bf16_f32 v143, v126, v127
    v_mfma_f32_32x32x16_bf16 v[112:127], v[208:211], v[16:19], 0
    v_exp_f32 v96, v96
    v_exp_f32 v97, v97
    v_exp_f32 v98, v98
    v_exp_f32 v99, v99
    v_cvt_pk_bf16_f32 v128, v96, v97
    v_cvt_pk_bf16_f32 v129, v98, v99
    v_mfma_f32_32x32x16_bf16 v[112:127], v[212:215], v[20:23], v[112:127]
    v_exp_f32 v100, v100
    v_exp_f32 v101, v101
    v_exp_f32 v102, v102
    v_exp_f32 v103, v103
    v_cvt_pk_bf16_f32 v130, v100, v101
    v_cvt_pk_bf16_f32 v131, v102, v103
    v_mfma_f32_32x32x16_bf16 v[48:63], v[216:219], v[136:139], v[48:63]
    v_exp_f32 v104, v104
    v_exp_f32 v105, v105
    v_exp_f32 v106, v106
    v_exp_f32 v107, v107
    v_cvt_pk_bf16_f32 v132, v104, v105
    v_cvt_pk_bf16_f32 v133, v106, v107
    v_mfma_f32_32x32x16_bf16 v[48:63], v[220:223], v[140:143], v[48:63]
    v_exp_f32 v108, v108
    v_exp_f32 v109, v109
    v_exp_f32 v110, v110
    v_exp_f32 v111, v111
    v_cvt_pk_bf16_f32 v134, v108, v109
    v_cvt_pk_bf16_f32 v135, v110, v111
    v_mfma_f32_32x32x16_bf16 v[96:111], v[232:235], v[24:27], 0
    v_exp_f32 v112, v112
    v_exp_f32 v113, v113
    v_exp_f32 v114, v114
    v_exp_f32 v115, v115
    v_cvt_pk_bf16_f32 v136, v112, v113
    v_cvt_pk_bf16_f32 v137, v114, v115
    v_mfma_f32_32x32x16_bf16 v[96:111], v[236:239], v[28:31], v[96:111]
    ds_write_b128 v249, v[48:51] offset:0
    v_exp_f32 v116, v116
    v_exp_f32 v117, v117
    v_exp_f32 v118, v118
    v_exp_f32 v119, v119
    v_cvt_pk_bf16_f32 v138, v116, v117
    v_cvt_pk_bf16_f32 v139, v118, v119
    v_mfma_f32_32x32x16_bf16 v[64:79], v[224:227], v[128:131], v[64:79]
    ds_write_b128 v249, v[52:55] offset:1024
    v_exp_f32 v120, v120
    v_exp_f32 v121, v121
    v_exp_f32 v122, v122
    v_exp_f32 v123, v123
    v_cvt_pk_bf16_f32 v140, v120, v121
    v_cvt_pk_bf16_f32 v141, v122, v123
    v_mfma_f32_32x32x16_bf16 v[64:79], v[228:231], v[132:135], v[64:79]
    ds_write_b128 v249, v[56:59] offset:2048
    v_exp_f32 v124, v124
    v_exp_f32 v125, v125
    v_exp_f32 v126, v126
    v_exp_f32 v127, v127
    v_cvt_pk_bf16_f32 v142, v124, v125
    v_cvt_pk_bf16_f32 v143, v126, v127
    v_mfma_f32_32x32x16_bf16 v[112:127], v[208:211], v[24:27], 0
    ds_write_b128 v249, v[60:63] offset:3072
    v_exp_f32 v96, v96
    v_exp_f32 v97, v97
    v_exp_f32 v98, v98
    v_exp_f32 v99, v99
    v_cvt_pk_bf16_f32 v128, v96, v97
    v_cvt_pk_bf16_f32 v129, v98, v99
    v_mfma_f32_32x32x16_bf16 v[112:127], v[212:215], v[28:31], v[112:127]
    v_exp_f32 v100, v100
    v_exp_f32 v101, v101
    v_exp_f32 v102, v102
    v_exp_f32 v103, v103
    v_cvt_pk_bf16_f32 v130, v100, v101
    v_cvt_pk_bf16_f32 v131, v102, v103
    v_mfma_f32_32x32x16_bf16 v[64:79], v[216:219], v[136:139], v[64:79]
    v_exp_f32 v104, v104
    v_exp_f32 v105, v105
    v_exp_f32 v106, v106
    v_exp_f32 v107, v107
    v_cvt_pk_bf16_f32 v132, v104, v105
    v_cvt_pk_bf16_f32 v133, v106, v107
    v_mfma_f32_32x32x16_bf16 v[64:79], v[220:223], v[140:143], v[64:79]
    v_exp_f32 v108, v108
    v_exp_f32 v109, v109
    v_exp_f32 v110, v110
    v_exp_f32 v111, v111
    v_cvt_pk_bf16_f32 v134, v108, v109
    v_cvt_pk_bf16_f32 v135, v110, v111
    v_mfma_f32_32x32x16_bf16 v[96:111], v[232:235], v[0:3], 0
    v_exp_f32 v112, v112
    v_exp_f32 v113, v113
    v_exp_f32 v114, v114
    v_exp_f32 v115, v115
    v_cvt_pk_bf16_f32 v136, v112, v113
    v_cvt_pk_bf16_f32 v137, v114, v115
    v_mfma_f32_32x32x16_bf16 v[96:111], v[236:239], v[4:7], v[96:111]
    ds_write_b128 v250, v[64:67] offset:4096
    v_exp_f32 v116, v116
    v_exp_f32 v117, v117
    v_exp_f32 v118, v118
    v_exp_f32 v119, v119
    v_cvt_pk_bf16_f32 v138, v116, v117
    v_cvt_pk_bf16_f32 v139, v118, v119
    v_mfma_f32_32x32x16_bf16 v[80:95], v[224:227], v[128:131], v[80:95]
    ds_write_b128 v250, v[68:71] offset:5120
    v_exp_f32 v120, v120
    v_exp_f32 v121, v121
    v_exp_f32 v122, v122
    v_exp_f32 v123, v123
    v_cvt_pk_bf16_f32 v140, v120, v121
    v_cvt_pk_bf16_f32 v141, v122, v123
    v_mfma_f32_32x32x16_bf16 v[80:95], v[228:231], v[132:135], v[80:95]
    ds_write_b128 v250, v[72:75] offset:6144
    v_exp_f32 v124, v124
    v_exp_f32 v125, v125
    v_exp_f32 v126, v126
    v_exp_f32 v127, v127
    v_cvt_pk_bf16_f32 v142, v124, v125
    v_cvt_pk_bf16_f32 v143, v126, v127
    v_mfma_f32_32x32x16_bf16 v[112:127], v[208:211], v[0:3], 0
    ds_write_b128 v250, v[76:79] offset:7168
    v_exp_f32 v96, v96
    v_exp_f32 v97, v97
    v_exp_f32 v98, v98
    v_exp_f32 v99, v99
    v_cvt_pk_bf16_f32 v128, v96, v97
    v_cvt_pk_bf16_f32 v129, v98, v99
    v_mfma_f32_32x32x16_bf16 v[112:127], v[212:215], v[4:7], v[112:127]
    v_exp_f32 v100, v100
    v_exp_f32 v101, v101
    v_exp_f32 v102, v102
    v_exp_f32 v103, v103
    v_cvt_pk_bf16_f32 v130, v100, v101
    v_cvt_pk_bf16_f32 v131, v102, v103
    v_mfma_f32_32x32x16_bf16 v[80:95], v[216:219], v[136:139], v[80:95]
    v_exp_f32 v104, v104
    v_exp_f32 v105, v105
    v_exp_f32 v106, v106
    v_exp_f32 v107, v107
    v_cvt_pk_bf16_f32 v132, v104, v105
    v_cvt_pk_bf16_f32 v133, v106, v107
    v_mfma_f32_32x32x16_bf16 v[80:95], v[220:223], v[140:143], v[80:95]
    v_exp_f32 v108, v108
    v_exp_f32 v109, v109
    v_exp_f32 v110, v110
    v_exp_f32 v111, v111
    v_cvt_pk_bf16_f32 v134, v108, v109
    v_cvt_pk_bf16_f32 v135, v110, v111
    v_exp_f32 v112, v112
    v_exp_f32 v113, v113
    v_exp_f32 v114, v114
    v_exp_f32 v115, v115
    v_cvt_pk_bf16_f32 v136, v112, v113
    v_cvt_pk_bf16_f32 v137, v114, v115
    ds_write_b128 v251, v[80:83] offset:8192
    v_exp_f32 v116, v116
    v_exp_f32 v117, v117
    v_exp_f32 v118, v118
    v_exp_f32 v119, v119
    v_cvt_pk_bf16_f32 v138, v116, v117
    v_cvt_pk_bf16_f32 v139, v118, v119
    v_mfma_f32_32x32x16_bf16 v[32:47], v[224:227], v[128:131], v[32:47]
    ds_write_b128 v251, v[84:87] offset:9216
    v_exp_f32 v120, v120
    v_exp_f32 v121, v121
    v_exp_f32 v122, v122
    v_exp_f32 v123, v123
    v_cvt_pk_bf16_f32 v140, v120, v121
    v_cvt_pk_bf16_f32 v141, v122, v123
    v_mfma_f32_32x32x16_bf16 v[32:47], v[228:231], v[132:135], v[32:47]
    ds_write_b128 v251, v[88:91] offset:10240
    v_exp_f32 v124, v124
    v_exp_f32 v125, v125
    v_exp_f32 v126, v126
    v_exp_f32 v127, v127
    v_cvt_pk_bf16_f32 v142, v124, v125
    v_cvt_pk_bf16_f32 v143, v126, v127
    s_nop 0
    v_mfma_f32_32x32x16_bf16 v[32:47], v[216:219], v[136:139], v[32:47]
    v_mfma_f32_32x32x16_bf16 v[32:47], v[220:223], v[140:143], v[32:47]
    ds_write_b128 v251, v[92:95] offset:11264
    s_mov_b32 s34, 0x08800000
    s_waitcnt lgkmcnt(0)
    s_barrier
    ds_read_b128 v[48:51], v248 offset:0
    ds_read_b128 v[52:55], v248 offset:1024
    ds_read_b128 v[56:59], v248 offset:2048
    ds_read_b128 v[60:63], v248 offset:3072
    ds_read_b128 v[64:67], v248 offset:4096
    ds_read_b128 v[68:71], v248 offset:5120
    ds_read_b128 v[72:75], v248 offset:6144
    ds_read_b128 v[76:79], v248 offset:7168
    ds_read_b128 v[80:83], v248 offset:8192
    ds_read_b128 v[84:87], v248 offset:9216
    ds_read_b128 v[88:91], v248 offset:10240
    ds_read_b128 v[92:95], v248 offset:11264
    s_waitcnt lgkmcnt(8)
    v_pk_add_f32 v[32:33], v[32:33], v[48:49]
    v_pk_add_f32 v[34:35], v[34:35], v[50:51]
    v_pk_add_f32 v[36:37], v[36:37], v[52:53]
    v_pk_add_f32 v[38:39], v[38:39], v[54:55]
    v_pk_add_f32 v[40:41], v[40:41], v[56:57]
    v_pk_add_f32 v[42:43], v[42:43], v[58:59]
    v_pk_add_f32 v[44:45], v[44:45], v[60:61]
    v_pk_add_f32 v[46:47], v[46:47], v[62:63]
    s_waitcnt lgkmcnt(4)
    v_pk_add_f32 v[32:33], v[32:33], v[64:65]
    v_pk_add_f32 v[34:35], v[34:35], v[66:67]
    v_pk_add_f32 v[36:37], v[36:37], v[68:69]
    v_pk_add_f32 v[38:39], v[38:39], v[70:71]
    v_pk_add_f32 v[40:41], v[40:41], v[72:73]
    v_pk_add_f32 v[42:43], v[42:43], v[74:75]
    v_pk_add_f32 v[44:45], v[44:45], v[76:77]
    v_pk_add_f32 v[46:47], v[46:47], v[78:79]
    s_waitcnt lgkmcnt(0)
    v_pk_add_f32 v[32:33], v[32:33], v[80:81]
    v_pk_add_f32 v[34:35], v[34:35], v[82:83]
    v_pk_add_f32 v[36:37], v[36:37], v[84:85]
    v_pk_add_f32 v[38:39], v[38:39], v[86:87]
    v_pk_add_f32 v[40:41], v[40:41], v[88:89]
    v_pk_add_f32 v[42:43], v[42:43], v[90:91]
    v_pk_add_f32 v[44:45], v[44:45], v[92:93]
    v_pk_add_f32 v[46:47], v[46:47], v[94:95]
    v_mov_b32 v242, v44
    v_mov_b32 v243, v44
    v_pk_mul_f32 v[244:245], v[32:33], 0 op_sel_hi:[1,0]
    v_pk_fma_f32 v[244:245], v[34:35], 0, v[244:245] op_sel_hi:[1,0,1]
    v_permlane32_swap_b32 v242, v243
    v_pk_fma_f32 v[244:245], v[36:37], 0, v[244:245] op_sel_hi:[1,0,1]
    v_pk_fma_f32 v[244:245], v[38:39], 0, v[244:245] op_sel_hi:[1,0,1]
    v_pk_fma_f32 v[244:245], v[40:41], 0, v[244:245] op_sel_hi:[1,0,1]
    v_pk_fma_f32 v[244:245], v[42:43], 0, v[244:245] op_sel_hi:[1,0,1]
    v_pk_fma_f32 v[244:245], v[44:45], 0, v[244:245] op_sel_hi:[1,0,1]
    v_pk_fma_f32 v[244:245], v[46:47], 0, v[244:245] op_sel_hi:[1,0,1]
    v_cmp_nge_f32 s[36:37], v243, s34
    v_cmp_u_f32 vcc, v244, v245
    s_nop 0
    s_or_b64 vcc, vcc, s[36:37]
    s_cbranch_vccnz L_k2_slow
L_k2_fin:
    v_rcp_f32 v243, v243
    s_nop 0
    v_mul_f32 v32, v32, v243
    v_mul_f32 v33, v33, v243
    v_mul_f32 v34, v34, v243
    v_mul_f32 v35, v35, v243
    v_mul_f32 v36, v36, v243
    v_mul_f32 v37, v37, v243
    v_mul_f32 v38, v38, v243
    v_mul_f32 v39, v39, v243
    v_mul_f32 v40, v40, v243
    v_mul_f32 v41, v41, v243
    v_mul_f32 v42, v42, v243
    v_mul_f32 v43, v43, v243
    v_mul_f32 v44, v44, v243
    v_mul_f32 v45, v45, v243
    v_mul_f32 v46, v46, v243
    v_mul_f32 v47, v47, v243
    v_cvt_pk_bf16_f32 v128, v32, v33
    v_cvt_pk_bf16_f32 v129, v34, v35
    v_cvt_pk_bf16_f32 v130, v36, v37
    v_cvt_pk_bf16_f32 v131, v38, v39
    v_cvt_pk_bf16_f32 v132, v40, v41
    v_cvt_pk_bf16_f32 v133, v42, v43
    v_cvt_pk_bf16_f32 v134, v44, v45
    v_cvt_pk_bf16_f32 v135, v46, v47
    s_mov_b32 exec_lo, 0
    v_mov_b32 v134, 0
    v_mov_b32 v135, 0
    s_mov_b32 exec_lo, -1
    buffer_store_dwordx4 v[128:131], v240, s[8:11], s32 offen sc0 sc1
    buffer_store_dwordx4 v[132:135], v240, s[8:11], s32 offen offset:1024 sc0 sc1
    s_waitcnt vmcnt(0)
    buffer_store_dword v247, v246, s[8:11], s31 offen sc0 sc1
    s_endpgm
L_k2_slow:
    s_waitcnt vmcnt(0)
    s_add_u32 s41, s33, 10485760
    s_add_u32 s40, s33, 8388608
    v_mov_b32 v244, 0xff800000
    s_mov_b32 exec_lo, 0
    v_mov_b32 v6, 0
    s_mov_b32 exec_lo, -1
    v_mov_b32 v32, 0
    v_mov_b32 v33, 0
    v_mov_b32 v34, 0
    v_mov_b32 v35, 0
    v_mov_b32 v36, 0
    v_mov_b32 v37, 0
    v_mov_b32 v38, 0
    v_mov_b32 v39, 0
    v_mov_b32 v40, 0
    v_mov_b32 v41, 0
    v_mov_b32 v42, 0
    v_mov_b32 v43, 0
    v_mov_b32 v44, 0
    v_mov_b32 v45, 0
    v_mov_b32 v46, 0
    v_mov_b32 v47, 0
    s_mov_b32 s14, 0
L_k2_slow_loop:
    buffer_load_dwordx4 v[144:147], v240, s[8:11], s40 offen
    buffer_load_dwordx4 v[148:151], v240, s[8:11], s40 offen offset:1024
    buffer_load_dwordx4 v[152:155], v240, s[8:11], s41 offen
    buffer_load_dwordx4 v[156:159], v240, s[8:11], s41 offen offset:1024
    s_waitcnt vmcnt(0)
    v_mfma_f32_32x32x16_bf16 v[96:111], v[144:147], v[0:3], 0
    v_mfma_f32_32x32x16_bf16 v[96:111], v[148:151], v[4:7], v[96:111]
    s_nop 7
    s_nop 4
    v_max3_f32 v242, v244, v96, v97
    v_max3_f32 v242, v242, v98, v99
    v_max3_f32 v242, v242, v100, v101
    v_max3_f32 v242, v242, v102, v103
    v_max3_f32 v242, v242, v104, v105
    v_max3_f32 v242, v242, v106, v107
    v_max3_f32 v242, v242, v108, v109
    v_max3_f32 v242, v242, v110, v111
    v_mov_b32 v243, v242
    s_nop 1
    v_permlane32_swap_b32 v242, v243
    s_nop 1
    v_max_f32 v242, v242, v243
    v_sub_f32 v243, v244, v242
    v_exp_f32 v243, v243
    v_mov_b32 v244, v242
    v_mul_f32 v32, v32, v243
    v_mul_f32 v33, v33, v243
    v_mul_f32 v34, v34, v243
    v_mul_f32 v35, v35, v243
    v_mul_f32 v36, v36, v243
    v_mul_f32 v37, v37, v243
    v_mul_f32 v38, v38, v243
    v_mul_f32 v39, v39, v243
    v_mul_f32 v40, v40, v243
    v_mul_f32 v41, v41, v243
    v_mul_f32 v42, v42, v243
    v_mul_f32 v43, v43, v243
    v_mul_f32 v44, v44, v243
    v_mul_f32 v45, v45, v243
    v_mul_f32 v46, v46, v243
    v_mul_f32 v47, v47, v243
    v_sub_f32 v96, v96, v244
    v_sub_f32 v97, v97, v244
    v_sub_f32 v98, v98, v244
    v_sub_f32 v99, v99, v244
    v_sub_f32 v100, v100, v244
    v_sub_f32 v101, v101, v244
    v_sub_f32 v102, v102, v244
    v_sub_f32 v103, v103, v244
    v_sub_f32 v104, v104, v244
    v_sub_f32 v105, v105, v244
    v_sub_f32 v106, v106, v244
    v_sub_f32 v107, v107, v244
    v_sub_f32 v108, v108, v244
    v_sub_f32 v109, v109, v244
    v_sub_f32 v110, v110, v244
    v_sub_f32 v111, v111, v244
    v_exp_f32 v96, v96
    v_exp_f32 v97, v97
    v_exp_f32 v98, v98
    v_exp_f32 v99, v99
    v_exp_f32 v100, v100
    v_exp_f32 v101, v101
    v_exp_f32 v102, v102
    v_exp_f32 v103, v103
    v_exp_f32 v104, v104
    v_exp_f32 v105, v105
    v_exp_f32 v106, v106
    v_exp_f32 v107, v107
    v_exp_f32 v108, v108
    v_exp_f32 v109, v109
    v_exp_f32 v110, v110
    v_exp_f32 v111, v111
    s_nop 0
    v_cvt_pk_bf16_f32 v128, v96, v97
    v_cvt_pk_bf16_f32 v129, v98, v99
    v_cvt_pk_bf16_f32 v130, v100, v101
    v_cvt_pk_bf16_f32 v131, v102, v103
    v_cvt_pk_bf16_f32 v132, v104, v105
    v_cvt_pk_bf16_f32 v133, v106, v107
    v_cvt_pk_bf16_f32 v134, v108, v109
    v_cvt_pk_bf16_f32 v135, v110, v111
    s_nop 1
    v_mfma_f32_32x32x16_bf16 v[32:47], v[152:155], v[128:131], v[32:47]
    v_mfma_f32_32x32x16_bf16 v[32:47], v[156:159], v[132:135], v[32:47]
    s_add_u32 s40, s40, 2048
    s_add_u32 s41, s41, 2048
    s_add_u32 s14, s14, 1
    s_nop 7
    s_nop 4
    s_cmp_lt_u32 s14, 64
    s_cbranch_scc1 L_k2_slow_loop
    v_mov_b32 v242, v44
    v_mov_b32 v243, v44
    s_nop 1
    v_permlane32_swap_b32 v242, v243
    s_nop 1
    s_branch L_k2_fin
L_k2_H:
    s_setprio 0
    s_load_dwordx2 s[44:45], s[0:1], 16
    s_load_dwordx4 s[48:51], s[0:1], 40
    s_bfe_u32 s28, s2, 0x30003
    s_and_b32 s27, s2, 7
    s_lshl_b32 s27, s27, 2
    s_bfe_u32 s34, s2, 0x20006
    s_add_u32 s27, s27, s34
    s_lshl_b32 s27, s27, 1
    s_lshr_b32 s34, s6, 1
    s_add_u32 s27, s27, s34
    s_and_b32 s29, s6, 1
    s_lshl_b32 s34, s27, 15
    s_add_u32 s22, s34, 12582912
    s_lshl_b32 s34, s27, 7
    s_add_u32 s24, s34, 16777216
    s_lshl_b32 s25, s6, 10
    s_lshl_b32 s30, s28, 7
    v_lshrrev_b32 v242, 3, v241
    v_and_b32 v243, 7, v241
    v_lshrrev_b32 v244, 4, v241
    v_lshlrev_b32 v245, 1, v244
    v_xor_b32 v245, v245, v243
    v_mul_u32_u24 v96, 896, v242
    v_lshl_add_u32 v96, v245, 4, v96
    s_mul_i32 s34, s6, 7168
    s_add_u32 s34, s34, s30
    v_add_u32 v96, s34, v96
    s_mul_i32 s34, s6, 2304
    s_add_u32 s34, s34, 115712
    v_and_b32 v97, 15, v241
    v_mul_u32_u24 v245, 144, v97
    v_lshl_add_u32 v245, v244, 3, v245
    v_add_u32 v98, s34, v245
    v_mul_u32_u24 v245, 144, v242
    v_lshl_add_u32 v245, v243, 4, v245
    v_add_u32 v99, s34, v245
    s_lshr_b32 s34, s27, 1
    s_lshl_b32 s34, s34, 6
    s_and_b32 s35, s27, 1
    s_add_u32 s34, s34, s35
    s_lshl_b32 s35, s29, 5
    s_add_u32 s34, s34, s35
    s_mul_i32 s34, s34, 1792
    s_add_u32 s34, s34, s30
    v_mul_u32_u24 v245, 3584, v242
    v_lshl_add_u32 v245, v243, 4, v245
    v_add_u32 v100, s34, v245
    s_lshl_b32 s34, s27, 5
    s_lshl_b32 s35, s29, 4
    s_add_u32 s34, s34, s35
    s_mul_i32 s34, s34, 1792
    s_add_u32 s34, s34, s30
    s_add_u32 s34, s34, 896
    v_mul_u32_u24 v245, 1792, v242
    v_lshl_add_u32 v245, v243, 4, v245
    v_add_u32 v101, s34, v245
    v_lshlrev_b32 v97, 4, v97
    v_lshrrev_b32 v242, 5, v241
    v_lshl_add_u32 v97, v242, 10, v97
    v_bfe_u32 v243, v241, 4, 1
    v_lshl_add_u32 v97, v243, 9, v97
    s_lshl_b32 s34, s29, 8
    v_add_u32 v97, s34, v97
    v_lshlrev_b32 v242, 4, v242
    v_lshl_add_u32 v242, v243, 2, v242
    v_bfe_u32 v243, v241, 2, 2
    v_add_u32 v242, v242, v243
    v_bfe_u32 v243, v242, 1, 2
    v_lshlrev_b32 v242, 7, v242
    v_and_b32 v245, 3, v241
    v_lshl_add_u32 v242, v245, 3, v242
    v_cmp_eq_u32 vcc, 3, v244
    v_mov_b32 v245, 0
    v_mov_b32 v102, 1024
    v_cndmask_b32 v244, v245, v102, vcc
    v_xor_b32 v245, 0, v243
    v_lshl_add_u32 v88, v245, 5, v242
    v_sub_u32 v92, v88, v244
    v_xor_b32 v245, 1, v243
    v_lshl_add_u32 v89, v245, 5, v242
    v_sub_u32 v93, v89, v244
    v_xor_b32 v245, 2, v243
    v_lshl_add_u32 v90, v245, 5, v242
    v_sub_u32 v94, v90, v244
    v_xor_b32 v245, 3, v243
    v_lshl_add_u32 v91, v245, 5, v242
    v_sub_u32 v95, v91, v244
    v_lshlrev_b32 v102, 2, v241
    s_waitcnt lgkmcnt(0)
    s_and_b32 s9, s9, 0xffff
    s_barrier
    s_cmp_eq_u32 s28, 7
    s_cbranch_scc1 L_k2_end
    s_mov_b32 s12, s44
    s_and_b32 s13, s45, 0xffff
    s_mov_b32 s14, 401408
    s_mov_b32 s15, 0x20000
    s_mov_b32 s16, s50
    s_and_b32 s17, s51, 0xffff
    s_mov_b32 s18, 3670016
    s_mov_b32 s19, 0x20000
    s_barrier
    s_setprio 3
    s_mov_b64 exec, 0xffff
    buffer_load_dword v242, v102, s[8:11], s24 offen sc0 sc1
    s_mov_b64 exec, -1
    s_add_u32 m0, s25, 0
    s_nop 0
    buffer_load_dwordx4 v96, s[12:15], 0 offen lds
    s_mov_b32 s34, 28672
    s_add_u32 m0, s25, 4096
    s_nop 0
    buffer_load_dwordx4 v96, s[12:15], s34 offen lds
    s_mov_b32 s34, 57344
    s_add_u32 m0, s25, 8192
    s_nop 0
    buffer_load_dwordx4 v96, s[12:15], s34 offen lds
    s_mov_b32 s34, 86016
    s_add_u32 m0, s25, 12288
    s_nop 0
    buffer_load_dwordx4 v96, s[12:15], s34 offen lds
    s_mov_b32 s34, 114688
    s_add_u32 m0, s25, 16384
    s_nop 0
    buffer_load_dwordx4 v96, s[12:15], s34 offen lds
    s_mov_b32 s34, 143360
    s_add_u32 m0, s25, 20480
    s_nop 0
    buffer_load_dwordx4 v96, s[12:15], s34 offen lds
    s_mov_b32 s34, 172032
    s_add_u32 m0, s25, 24576
    s_nop 0
    buffer_load_dwordx4 v96, s[12:15], s34 offen lds
    s_mov_b32 s34, 200704
    s_add_u32 m0, s25, 28672
    s_nop 0
    buffer_load_dwordx4 v96, s[12:15], s34 offen lds
    s_mov_b32 s34, 229376
    s_add_u32 m0, s25, 32768
    s_nop 0
    buffer_load_dwordx4 v96, s[12:15], s34 offen lds
    s_mov_b32 s34, 258048
    s_add_u32 m0, s25, 36864
    s_nop 0
    buffer_load_dwordx4 v96, s[12:15], s34 offen lds
    s_mov_b32 s34, 286720
    s_add_u32 m0, s25, 40960
    s_nop 0
    buffer_load_dwordx4 v96, s[12:15], s34 offen lds
    s_mov_b32 s34, 315392
    s_add_u32 m0, s25, 45056
    s_nop 0
    buffer_load_dwordx4 v96, s[12:15], s34 offen lds
    s_mov_b32 s34, 344064
    s_add_u32 m0, s25, 49152
    s_nop 0
    buffer_load_dwordx4 v96, s[12:15], s34 offen lds
    s_mov_b32 s34, 372736
    s_add_u32 m0, s25, 53248
    s_nop 0
    buffer_load_dwordx4 v96, s[12:15], s34 offen lds
    s_mov_b32 s12, s48
    s_and_b32 s13, s49, 0xffff
    s_add_u32 m0, s25, 57344
    s_nop 0
    buffer_load_dwordx4 v96, s[12:15], 0 offen lds
    s_mov_b32 s34, 28672
    s_add_u32 m0, s25, 61440
    s_nop 0
    buffer_load_dwordx4 v96, s[12:15], s34 offen lds
    s_mov_b32 s34, 57344
    s_add_u32 m0, s25, 65536
    s_nop 0
    buffer_load_dwordx4 v96, s[12:15], s34 offen lds
    s_mov_b32 s34, 86016
    s_add_u32 m0, s25, 69632
    s_nop 0
    buffer_load_dwordx4 v96, s[12:15], s34 offen lds
    s_mov_b32 s34, 114688
    s_add_u32 m0, s25, 73728
    s_nop 0
    buffer_load_dwordx4 v96, s[12:15], s34 offen lds
    s_mov_b32 s34, 143360
    s_add_u32 m0, s25, 77824
    s_nop 0
    buffer_load_dwordx4 v96, s[12:15], s34 offen lds
    s_mov_b32 s34, 172032
    s_add_u32 m0, s25, 81920
    s_nop 0
    buffer_load_dwordx4 v96, s[12:15], s34 offen lds
    s_mov_b32 s34, 200704
    s_add_u32 m0, s25, 86016
    s_nop 0
    buffer_load_dwordx4 v96, s[12:15], s34 offen lds
    s_mov_b32 s34, 229376
    s_add_u32 m0, s25, 90112
    s_nop 0
    buffer_load_dwordx4 v96, s[12:15], s34 offen lds
    s_mov_b32 s34, 258048
    s_add_u32 m0, s25, 94208
    s_nop 0
    buffer_load_dwordx4 v96, s[12:15], s34 offen lds
    s_mov_b32 s34, 286720
    s_add_u32 m0, s25, 98304
    s_nop 0
    buffer_load_dwordx4 v96, s[12:15], s34 offen lds
    s_mov_b32 s34, 315392
    s_add_u32 m0, s25, 102400
    s_nop 0
    buffer_load_dwordx4 v96, s[12:15], s34 offen lds
    s_mov_b32 s34, 344064
    s_add_u32 m0, s25, 106496
    s_nop 0
    buffer_load_dwordx4 v96, s[12:15], s34 offen lds
    s_mov_b32 s34, 372736
    s_add_u32 m0, s25, 110592
    s_nop 0
    buffer_load_dwordx4 v96, s[12:15], s34 offen lds
    s_waitcnt vmcnt(28)
    v_cmp_eq_u32 vcc, 1, v242
    s_nop 1
    s_and_b32 s36, vcc_lo, 0xffff
    s_cmp_eq_u32 s36, 0xffff
    s_cbranch_scc1 L_k2_Aok
    s_mov_b64 exec, 0xffff
    s_mov_b32 s35, 0
L_k2_pollA:
    buffer_load_dword v245, v102, s[8:11], s24 offen sc0 sc1
    s_waitcnt vmcnt(0)
    v_cmp_eq_u32 vcc, 1, v245
    s_add_u32 s35, s35, 1
    s_cmp_eq_u64 vcc, exec
    s_cbranch_scc1 L_k2_goA
    s_sleep 2
    s_cmp_lt_u32 s35, 0x40000
    s_cbranch_scc1 L_k2_pollA
L_k2_goA:
    s_mov_b64 exec, -1
L_k2_Aok:
    s_add_u32 s34, s22, 0
    buffer_load_dwordx4 v[0:3], v97, s[8:11], s34 offen sc1
    buffer_load_dwordx4 v[4:7], v97, s[8:11], s34 offen offset:2048 sc1
    s_add_u32 s34, s22, 4096
    buffer_load_dwordx4 v[8:11], v97, s[8:11], s34 offen sc1
    buffer_load_dwordx4 v[12:15], v97, s[8:11], s34 offen offset:2048 sc1
    s_add_u32 s34, s22, 8192
    buffer_load_dwordx4 v[16:19], v97, s[8:11], s34 offen sc1
    buffer_load_dwordx4 v[20:23], v97, s[8:11], s34 offen offset:2048 sc1
    s_add_u32 s34, s22, 12288
    buffer_load_dwordx4 v[24:27], v97, s[8:11], s34 offen sc1
    buffer_load_dwordx4 v[28:31], v97, s[8:11], s34 offen offset:2048 sc1
    s_add_u32 s34, s22, 16384
    buffer_load_dwordx4 v[32:35], v97, s[8:11], s34 offen sc1
    buffer_load_dwordx4 v[36:39], v97, s[8:11], s34 offen offset:2048 sc1
    s_add_u32 s34, s22, 20480
    buffer_load_dwordx4 v[40:43], v97, s[8:11], s34 offen sc1
    buffer_load_dwordx4 v[44:47], v97, s[8:11], s34 offen offset:2048 sc1
    s_add_u32 s34, s22, 24576
    buffer_load_dwordx4 v[48:51], v97, s[8:11], s34 offen sc1
    buffer_load_dwordx4 v[52:55], v97, s[8:11], s34 offen offset:2048 sc1
    s_add_u32 s34, s22, 28672
    buffer_load_dwordx4 v[56:59], v97, s[8:11], s34 offen sc1
    buffer_load_dwordx4 v[60:63], v97, s[8:11], s34 offen offset:2048 sc1
    s_waitcnt vmcnt(16)
    s_barrier
    s_setprio 0
    ds_read_b64_tr_b16 v[104:105], v88 offset:0
    ds_read_b64_tr_b16 v[106:107], v88 offset:1024
    ds_read_b64_tr_b16 v[108:109], v89 offset:0
    ds_read_b64_tr_b16 v[110:111], v89 offset:1024
    ds_read_b64_tr_b16 v[112:113], v90 offset:0
    ds_read_b64_tr_b16 v[114:115], v90 offset:1024
    ds_read_b64_tr_b16 v[116:117], v91 offset:0
    ds_read_b64_tr_b16 v[118:119], v91 offset:1024
    s_waitcnt lgkmcnt(4)
    ds_read_b64_tr_b16 v[120:121], v90 offset:3584
    ds_read_b64_tr_b16 v[122:123], v90 offset:4608
    ds_read_b64_tr_b16 v[124:125], v91 offset:3584
    ds_read_b64_tr_b16 v[126:127], v91 offset:4608
    ds_read_b64_tr_b16 v[128:129], v88 offset:3584
    ds_read_b64_tr_b16 v[130:131], v88 offset:4608
    ds_read_b64_tr_b16 v[132:133], v89 offset:3584
    ds_read_b64_tr_b16 v[134:135], v89 offset:4608
    s_waitcnt lgkmcnt(4)
    ds_read_b64_tr_b16 v[136:137], v88 offset:7168
    ds_read_b64_tr_b16 v[138:139], v88 offset:8192
    ds_read_b64_tr_b16 v[140:141], v89 offset:7168
    ds_read_b64_tr_b16 v[142:143], v89 offset:8192
    ds_read_b64_tr_b16 v[144:145], v90 offset:7168
    ds_read_b64_tr_b16 v[146:147], v90 offset:8192
    ds_read_b64_tr_b16 v[148:149], v91 offset:7168
    ds_read_b64_tr_b16 v[150:151], v91 offset:8192
    s_waitcnt lgkmcnt(4)
    ds_read_b64_tr_b16 v[152:153], v90 offset:10752
    ds_read_b64_tr_b16 v[154:155], v90 offset:11776
    ds_read_b64_tr_b16 v[156:157], v91 offset:10752
    ds_read_b64_tr_b16 v[158:159], v91 offset:11776
    ds_read_b64_tr_b16 v[160:161], v88 offset:10752
    ds_read_b64_tr_b16 v[162:163], v88 offset:11776
    ds_read_b64_tr_b16 v[164:165], v89 offset:10752
    ds_read_b64_tr_b16 v[166:167], v89 offset:11776
    s_waitcnt lgkmcnt(4)
    ds_read_b64_tr_b16 v[168:169], v88 offset:14336
    ds_read_b64_tr_b16 v[170:171], v88 offset:15360
    ds_read_b64_tr_b16 v[172:173], v89 offset:14336
    ds_read_b64_tr_b16 v[174:175], v89 offset:15360
    ds_read_b64_tr_b16 v[176:177], v90 offset:14336
    ds_read_b64_tr_b16 v[178:179], v90 offset:15360
    ds_read_b64_tr_b16 v[180:181], v91 offset:14336
    ds_read_b64_tr_b16 v[182:183], v91 offset:15360
    s_waitcnt lgkmcnt(4)
    ds_read_b64_tr_b16 v[184:185], v90 offset:17920
    ds_read_b64_tr_b16 v[186:187], v90 offset:18944
    ds_read_b64_tr_b16 v[188:189], v91 offset:17920
    ds_read_b64_tr_b16 v[190:191], v91 offset:18944
    ds_read_b64_tr_b16 v[192:193], v88 offset:17920
    ds_read_b64_tr_b16 v[194:195], v88 offset:18944
    ds_read_b64_tr_b16 v[196:197], v89 offset:17920
    ds_read_b64_tr_b16 v[198:199], v89 offset:18944
    s_waitcnt lgkmcnt(4)
    ds_read_b64_tr_b16 v[200:201], v88 offset:21504
    ds_read_b64_tr_b16 v[202:203], v88 offset:22528
    ds_read_b64_tr_b16 v[204:205], v89 offset:21504
    ds_read_b64_tr_b16 v[206:207], v89 offset:22528
    ds_read_b64_tr_b16 v[208:209], v90 offset:21504
    ds_read_b64_tr_b16 v[210:211], v90 offset:22528
    ds_read_b64_tr_b16 v[212:213], v91 offset:21504
    ds_read_b64_tr_b16 v[214:215], v91 offset:22528
    s_waitcnt lgkmcnt(4)
    ds_read_b64_tr_b16 v[216:217], v90 offset:25088
    ds_read_b64_tr_b16 v[218:219], v90 offset:26112
    ds_read_b64_tr_b16 v[220:221], v91 offset:25088
    ds_read_b64_tr_b16 v[222:223], v91 offset:26112
    ds_read_b64_tr_b16 v[224:225], v88 offset:25088
    ds_read_b64_tr_b16 v[226:227], v88 offset:26112
    ds_read_b64_tr_b16 v[228:229], v89 offset:25088
    ds_read_b64_tr_b16 v[230:231], v89 offset:26112
    s_waitcnt vmcnt(15) lgkmcnt(0)
    v_mfma_f32_16x16x32_bf16 v[64:67], v[104:107], v[0:3], 0
    v_mfma_f32_16x16x32_bf16 v[68:71], v[108:111], v[0:3], 0
    v_mfma_f32_16x16x32_bf16 v[72:75], v[112:115], v[0:3], 0
    v_mfma_f32_16x16x32_bf16 v[76:79], v[116:119], v[0:3], 0
    ds_read_b64_tr_b16 v[104:105], v88 offset:28672
    ds_read_b64_tr_b16 v[106:107], v88 offset:29696
    ds_read_b64_tr_b16 v[108:109], v89 offset:28672
    ds_read_b64_tr_b16 v[110:111], v89 offset:29696
    ds_read_b64_tr_b16 v[112:113], v90 offset:28672
    ds_read_b64_tr_b16 v[114:115], v90 offset:29696
    ds_read_b64_tr_b16 v[116:117], v91 offset:28672
    ds_read_b64_tr_b16 v[118:119], v91 offset:29696
    s_waitcnt vmcnt(14)
    v_mfma_f32_16x16x32_bf16 v[64:67], v[120:123], v[4:7], v[64:67]
    v_mfma_f32_16x16x32_bf16 v[68:71], v[124:127], v[4:7], v[68:71]
    v_mfma_f32_16x16x32_bf16 v[72:75], v[128:131], v[4:7], v[72:75]
    v_mfma_f32_16x16x32_bf16 v[76:79], v[132:135], v[4:7], v[76:79]
    s_waitcnt lgkmcnt(4)
    ds_read_b64_tr_b16 v[120:121], v90 offset:32256
    ds_read_b64_tr_b16 v[122:123], v90 offset:33280
    ds_read_b64_tr_b16 v[124:125], v91 offset:32256
    ds_read_b64_tr_b16 v[126:127], v91 offset:33280
    ds_read_b64_tr_b16 v[128:129], v88 offset:32256
    ds_read_b64_tr_b16 v[130:131], v88 offset:33280
    ds_read_b64_tr_b16 v[132:133], v89 offset:32256
    ds_read_b64_tr_b16 v[134:135], v89 offset:33280
    s_waitcnt vmcnt(13)
    v_mfma_f32_16x16x32_bf16 v[64:67], v[136:139], v[8:11], v[64:67]
    v_mfma_f32_16x16x32_bf16 v[68:71], v[140:143], v[8:11], v[68:71]
    v_mfma_f32_16x16x32_bf16 v[72:75], v[144:147], v[8:11], v[72:75]
    v_mfma_f32_16x16x32_bf16 v[76:79], v[148:151], v[8:11], v[76:79]
    s_waitcnt lgkmcnt(4)
    ds_read_b64_tr_b16 v[136:137], v88 offset:35840
    ds_read_b64_tr_b16 v[138:139], v88 offset:36864
    ds_read_b64_tr_b16 v[140:141], v89 offset:35840
    ds_read_b64_tr_b16 v[142:143], v89 offset:36864
    ds_read_b64_tr_b16 v[144:145], v90 offset:35840
    ds_read_b64_tr_b16 v[146:147], v90 offset:36864
    ds_read_b64_tr_b16 v[148:149], v91 offset:35840
    ds_read_b64_tr_b16 v[150:151], v91 offset:36864
    s_waitcnt vmcnt(12)
    v_mfma_f32_16x16x32_bf16 v[64:67], v[152:155], v[12:15], v[64:67]
    v_mfma_f32_16x16x32_bf16 v[68:71], v[156:159], v[12:15], v[68:71]
    v_mfma_f32_16x16x32_bf16 v[72:75], v[160:163], v[12:15], v[72:75]
    v_mfma_f32_16x16x32_bf16 v[76:79], v[164:167], v[12:15], v[76:79]
    s_waitcnt lgkmcnt(4)
    ds_read_b64_tr_b16 v[152:153], v90 offset:39424
    ds_read_b64_tr_b16 v[154:155], v90 offset:40448
    ds_read_b64_tr_b16 v[156:157], v91 offset:39424
    ds_read_b64_tr_b16 v[158:159], v91 offset:40448
    ds_read_b64_tr_b16 v[160:161], v88 offset:39424
    ds_read_b64_tr_b16 v[162:163], v88 offset:40448
    ds_read_b64_tr_b16 v[164:165], v89 offset:39424
    ds_read_b64_tr_b16 v[166:167], v89 offset:40448
    s_waitcnt vmcnt(11)
    v_mfma_f32_16x16x32_bf16 v[64:67], v[168:171], v[16:19], v[64:67]
    v_mfma_f32_16x16x32_bf16 v[68:71], v[172:175], v[16:19], v[68:71]
    v_mfma_f32_16x16x32_bf16 v[72:75], v[176:179], v[16:19], v[72:75]
    v_mfma_f32_16x16x32_bf16 v[76:79], v[180:183], v[16:19], v[76:79]
    s_waitcnt lgkmcnt(4)
    ds_read_b64_tr_b16 v[168:169], v88 offset:43008
    ds_read_b64_tr_b16 v[170:171], v88 offset:44032
    ds_read_b64_tr_b16 v[172:173], v89 offset:43008
    ds_read_b64_tr_b16 v[174:175], v89 offset:44032
    ds_read_b64_tr_b16 v[176:177], v90 offset:43008
    ds_read_b64_tr_b16 v[178:179], v90 offset:44032
    ds_read_b64_tr_b16 v[180:181], v91 offset:43008
    ds_read_b64_tr_b16 v[182:183], v91 offset:44032
    s_waitcnt vmcnt(10)
    v_mfma_f32_16x16x32_bf16 v[64:67], v[184:187], v[20:23], v[64:67]
    v_mfma_f32_16x16x32_bf16 v[68:71], v[188:191], v[20:23], v[68:71]
    v_mfma_f32_16x16x32_bf16 v[72:75], v[192:195], v[20:23], v[72:75]
    v_mfma_f32_16x16x32_bf16 v[76:79], v[196:199], v[20:23], v[76:79]
    s_waitcnt lgkmcnt(4)
    ds_read_b64_tr_b16 v[184:185], v90 offset:46592
    ds_read_b64_tr_b16 v[186:187], v90 offset:47616
    ds_read_b64_tr_b16 v[188:189], v91 offset:46592
    ds_read_b64_tr_b16 v[190:191], v91 offset:47616
    ds_read_b64_tr_b16 v[192:193], v88 offset:46592
    ds_read_b64_tr_b16 v[194:195], v88 offset:47616
    ds_read_b64_tr_b16 v[196:197], v89 offset:46592
    ds_read_b64_tr_b16 v[198:199], v89 offset:47616
    s_waitcnt vmcnt(9)
    v_mfma_f32_16x16x32_bf16 v[64:67], v[200:203], v[24:27], v[64:67]
    v_mfma_f32_16x16x32_bf16 v[68:71], v[204:207], v[24:27], v[68:71]
    v_mfma_f32_16x16x32_bf16 v[72:75], v[208:211], v[24:27], v[72:75]
    v_mfma_f32_16x16x32_bf16 v[76:79], v[212:215], v[24:27], v[76:79]
    s_waitcnt lgkmcnt(4)
    ds_read_b64_tr_b16 v[200:201], v88 offset:50176
    ds_read_b64_tr_b16 v[202:203], v88 offset:51200
    ds_read_b64_tr_b16 v[204:205], v89 offset:50176
    ds_read_b64_tr_b16 v[206:207], v89 offset:51200
    ds_read_b64_tr_b16 v[208:209], v90 offset:50176
    ds_read_b64_tr_b16 v[210:211], v90 offset:51200
    ds_read_b64_tr_b16 v[212:213], v91 offset:50176
    ds_read_b64_tr_b16 v[214:215], v91 offset:51200
    s_waitcnt vmcnt(8)
    v_mfma_f32_16x16x32_bf16 v[64:67], v[216:219], v[28:31], v[64:67]
    v_mfma_f32_16x16x32_bf16 v[68:71], v[220:223], v[28:31], v[68:71]
    v_mfma_f32_16x16x32_bf16 v[72:75], v[224:227], v[28:31], v[72:75]
    v_mfma_f32_16x16x32_bf16 v[76:79], v[228:231], v[28:31], v[76:79]
    s_waitcnt lgkmcnt(4)
    ds_read_b64_tr_b16 v[216:217], v90 offset:53760
    ds_read_b64_tr_b16 v[218:219], v94 offset:54784
    ds_read_b64_tr_b16 v[220:221], v91 offset:53760
    ds_read_b64_tr_b16 v[222:223], v95 offset:54784
    ds_read_b64_tr_b16 v[224:225], v88 offset:53760
    ds_read_b64_tr_b16 v[226:227], v92 offset:54784
    ds_read_b64_tr_b16 v[228:229], v89 offset:53760
    ds_read_b64_tr_b16 v[230:231], v93 offset:54784
    s_waitcnt vmcnt(7) lgkmcnt(7)
    v_mfma_f32_16x16x32_bf16 v[64:67], v[104:107], v[32:35], v[64:67]
    v_mfma_f32_16x16x32_bf16 v[68:71], v[108:111], v[32:35], v[68:71]
    v_mfma_f32_16x16x32_bf16 v[72:75], v[112:115], v[32:35], v[72:75]
    v_mfma_f32_16x16x32_bf16 v[76:79], v[116:119], v[32:35], v[76:79]
    s_waitcnt vmcnt(6) lgkmcnt(7)
    v_mfma_f32_16x16x32_bf16 v[64:67], v[120:123], v[36:39], v[64:67]
    v_mfma_f32_16x16x32_bf16 v[68:71], v[124:127], v[36:39], v[68:71]
    v_mfma_f32_16x16x32_bf16 v[72:75], v[128:131], v[36:39], v[72:75]
    v_mfma_f32_16x16x32_bf16 v[76:79], v[132:135], v[36:39], v[76:79]
    s_waitcnt vmcnt(5) lgkmcnt(7)
    v_mfma_f32_16x16x32_bf16 v[64:67], v[136:139], v[40:43], v[64:67]
    v_mfma_f32_16x16x32_bf16 v[68:71], v[140:143], v[40:43], v[68:71]
    v_mfma_f32_16x16x32_bf16 v[72:75], v[144:147], v[40:43], v[72:75]
    v_mfma_f32_16x16x32_bf16 v[76:79], v[148:151], v[40:43], v[76:79]
    s_waitcnt vmcnt(4) lgkmcnt(7)
    v_mfma_f32_16x16x32_bf16 v[64:67], v[152:155], v[44:47], v[64:67]
    v_mfma_f32_16x16x32_bf16 v[68:71], v[156:159], v[44:47], v[68:71]
    v_mfma_f32_16x16x32_bf16 v[72:75], v[160:163], v[44:47], v[72:75]
    v_mfma_f32_16x16x32_bf16 v[76:79], v[164:167], v[44:47], v[76:79]
    s_waitcnt vmcnt(3) lgkmcnt(7)
    v_mfma_f32_16x16x32_bf16 v[64:67], v[168:171], v[48:51], v[64:67]
    v_mfma_f32_16x16x32_bf16 v[68:71], v[172:175], v[48:51], v[68:71]
    v_mfma_f32_16x16x32_bf16 v[72:75], v[176:179], v[48:51], v[72:75]
    v_mfma_f32_16x16x32_bf16 v[76:79], v[180:183], v[48:51], v[76:79]
    s_waitcnt vmcnt(2) lgkmcnt(7)
    v_mfma_f32_16x16x32_bf16 v[64:67], v[184:187], v[52:55], v[64:67]
    v_mfma_f32_16x16x32_bf16 v[68:71], v[188:191], v[52:55], v[68:71]
    v_mfma_f32_16x16x32_bf16 v[72:75], v[192:195], v[52:55], v[72:75]
    v_mfma_f32_16x16x32_bf16 v[76:79], v[196:199], v[52:55], v[76:79]
    s_waitcnt vmcnt(1) lgkmcnt(7)
    v_mfma_f32_16x16x32_bf16 v[64:67], v[200:203], v[56:59], v[64:67]
    v_mfma_f32_16x16x32_bf16 v[68:71], v[204:207], v[56:59], v[68:71]
    v_mfma_f32_16x16x32_bf16 v[72:75], v[208:211], v[56:59], v[72:75]
    v_mfma_f32_16x16x32_bf16 v[76:79], v[212:215], v[56:59], v[76:79]
    s_waitcnt vmcnt(0) lgkmcnt(0)
    v_mfma_f32_16x16x32_bf16 v[64:67], v[216:219], v[60:63], v[64:67]
    v_mfma_f32_16x16x32_bf16 v[68:71], v[220:223], v[60:63], v[68:71]
    v_mfma_f32_16x16x32_bf16 v[72:75], v[224:227], v[60:63], v[72:75]
    v_mfma_f32_16x16x32_bf16 v[76:79], v[228:231], v[60:63], v[76:79]
    s_nop 4
    v_cvt_pk_bf16_f32 v80, v64, v65
    v_cvt_pk_bf16_f32 v81, v66, v67
    v_cvt_pk_bf16_f32 v82, v68, v69
    v_cvt_pk_bf16_f32 v83, v70, v71
    v_cvt_pk_bf16_f32 v84, v72, v73
    v_cvt_pk_bf16_f32 v85, v74, v75
    v_cvt_pk_bf16_f32 v86, v76, v77
    v_cvt_pk_bf16_f32 v87, v78, v79
    v_add_u32 v88, 57344, v88
    v_add_u32 v89, 57344, v89
    v_add_u32 v90, 57344, v90
    v_add_u32 v91, 57344, v91
    v_add_u32 v92, 57344, v92
    v_add_u32 v93, 57344, v93
    v_add_u32 v94, 57344, v94
    v_add_u32 v95, 57344, v95
    s_add_u32 s22, s22, 0x200000
    s_add_u32 s24, s24, 8192
    s_mov_b64 exec, 0xffff
    buffer_load_dword v244, v102, s[8:11], s24 offen sc0 sc1
    s_mov_b64 exec, -1
    ds_read_b64_tr_b16 v[104:105], v88 offset:0
    ds_read_b64_tr_b16 v[106:107], v88 offset:1024
    ds_read_b64_tr_b16 v[108:109], v89 offset:0
    ds_read_b64_tr_b16 v[110:111], v89 offset:1024
    ds_read_b64_tr_b16 v[112:113], v90 offset:0
    ds_read_b64_tr_b16 v[114:115], v90 offset:1024
    ds_read_b64_tr_b16 v[116:117], v91 offset:0
    ds_read_b64_tr_b16 v[118:119], v91 offset:1024
    s_waitcnt lgkmcnt(4)
    ds_read_b64_tr_b16 v[120:121], v90 offset:3584
    ds_read_b64_tr_b16 v[122:123], v90 offset:4608
    ds_read_b64_tr_b16 v[124:125], v91 offset:3584
    ds_read_b64_tr_b16 v[126:127], v91 offset:4608
    ds_read_b64_tr_b16 v[128:129], v88 offset:3584
    ds_read_b64_tr_b16 v[130:131], v88 offset:4608
    ds_read_b64_tr_b16 v[132:133], v89 offset:3584
    ds_read_b64_tr_b16 v[134:135], v89 offset:4608
    s_waitcnt lgkmcnt(4)
    ds_read_b64_tr_b16 v[136:137], v88 offset:7168
    ds_read_b64_tr_b16 v[138:139], v88 offset:8192
    ds_read_b64_tr_b16 v[140:141], v89 offset:7168
    ds_read_b64_tr_b16 v[142:143], v89 offset:8192
    ds_read_b64_tr_b16 v[144:145], v90 offset:7168
    ds_read_b64_tr_b16 v[146:147], v90 offset:8192
    ds_read_b64_tr_b16 v[148:149], v91 offset:7168
    ds_read_b64_tr_b16 v[150:151], v91 offset:8192
    s_waitcnt lgkmcnt(4)
    ds_read_b64_tr_b16 v[152:153], v90 offset:10752
    ds_read_b64_tr_b16 v[154:155], v90 offset:11776
    ds_read_b64_tr_b16 v[156:157], v91 offset:10752
    ds_read_b64_tr_b16 v[158:159], v91 offset:11776
    ds_read_b64_tr_b16 v[160:161], v88 offset:10752
    ds_read_b64_tr_b16 v[162:163], v88 offset:11776
    ds_read_b64_tr_b16 v[164:165], v89 offset:10752
    ds_read_b64_tr_b16 v[166:167], v89 offset:11776
    s_waitcnt lgkmcnt(4)
    ds_read_b64_tr_b16 v[168:169], v88 offset:14336
    ds_read_b64_tr_b16 v[170:171], v88 offset:15360
    ds_read_b64_tr_b16 v[172:173], v89 offset:14336
    ds_read_b64_tr_b16 v[174:175], v89 offset:15360
    ds_read_b64_tr_b16 v[176:177], v90 offset:14336
    ds_read_b64_tr_b16 v[178:179], v90 offset:15360
    ds_read_b64_tr_b16 v[180:181], v91 offset:14336
    ds_read_b64_tr_b16 v[182:183], v91 offset:15360
    s_waitcnt lgkmcnt(4)
    ds_read_b64_tr_b16 v[184:185], v90 offset:17920
    ds_read_b64_tr_b16 v[186:187], v90 offset:18944
    ds_read_b64_tr_b16 v[188:189], v91 offset:17920
    ds_read_b64_tr_b16 v[190:191], v91 offset:18944
    ds_read_b64_tr_b16 v[192:193], v88 offset:17920
    ds_read_b64_tr_b16 v[194:195], v88 offset:18944
    ds_read_b64_tr_b16 v[196:197], v89 offset:17920
    ds_read_b64_tr_b16 v[198:199], v89 offset:18944
    s_waitcnt lgkmcnt(4)
    ds_read_b64_tr_b16 v[200:201], v88 offset:21504
    ds_read_b64_tr_b16 v[202:203], v88 offset:22528
    ds_read_b64_tr_b16 v[204:205], v89 offset:21504
    ds_read_b64_tr_b16 v[206:207], v89 offset:22528
    ds_read_b64_tr_b16 v[208:209], v90 offset:21504
    ds_read_b64_tr_b16 v[210:211], v90 offset:22528
    ds_read_b64_tr_b16 v[212:213], v91 offset:21504
    ds_read_b64_tr_b16 v[214:215], v91 offset:22528
    s_waitcnt lgkmcnt(4)
    ds_read_b64_tr_b16 v[216:217], v90 offset:25088
    ds_read_b64_tr_b16 v[218:219], v90 offset:26112
    ds_read_b64_tr_b16 v[220:221], v91 offset:25088
    ds_read_b64_tr_b16 v[222:223], v91 offset:26112
    ds_read_b64_tr_b16 v[224:225], v88 offset:25088
    ds_read_b64_tr_b16 v[226:227], v88 offset:26112
    ds_read_b64_tr_b16 v[228:229], v89 offset:25088
    ds_read_b64_tr_b16 v[230:231], v89 offset:26112
    s_mov_b64 exec, 0xffff
    s_mov_b32 s35, 0
L_k2_pollB:
    buffer_load_dword v245, v102, s[8:11], s24 offen sc0 sc1
    s_waitcnt vmcnt(1)
    v_cmp_eq_u32 vcc, 1, v244
    s_add_u32 s35, s35, 1
    s_cmp_eq_u64 vcc, exec
    s_cbranch_scc1 L_k2_goB
    s_sleep 2
    buffer_load_dword v244, v102, s[8:11], s24 offen sc0 sc1
    s_waitcnt vmcnt(1)
    v_cmp_eq_u32 vcc, 1, v245
    s_add_u32 s35, s35, 1
    s_cmp_eq_u64 vcc, exec
    s_cbranch_scc1 L_k2_goB
    s_sleep 2
    s_cmp_lt_u32 s35, 0x80000
    s_cbranch_scc1 L_k2_pollB
L_k2_goB:
    s_mov_b64 exec, -1
    s_add_u32 s34, s22, 0
    buffer_load_dwordx4 v[0:3], v97, s[8:11], s34 offen sc1
    s_add_u32 s34, s22, 2048
    buffer_load_dwordx4 v[4:7], v97, s[8:11], s34 offen sc1
    s_add_u32 s34, s22, 4096
    buffer_load_dwordx4 v[8:11], v97, s[8:11], s34 offen sc1
    s_add_u32 s34, s22, 6144
    buffer_load_dwordx4 v[12:15], v97, s[8:11], s34 offen sc1
    s_add_u32 s34, s22, 8192
    buffer_load_dwordx4 v[16:19], v97, s[8:11], s34 offen sc1
    s_add_u32 s34, s22, 10240
    buffer_load_dwordx4 v[20:23], v97, s[8:11], s34 offen sc1
    s_add_u32 s34, s22, 12288
    buffer_load_dwordx4 v[24:27], v97, s[8:11], s34 offen sc1
    s_add_u32 s34, s22, 14336
    buffer_load_dwordx4 v[28:31], v97, s[8:11], s34 offen sc1
    s_barrier
    ds_write_b64 v98, v[80:81] offset:0
    ds_write_b64 v98, v[82:83] offset:32
    ds_write_b64 v98, v[84:85] offset:64
    ds_write_b64 v98, v[86:87] offset:96
    s_movk_i32 s34, 28672
    s_waitcnt lgkmcnt(0)
    ds_read_b128 v[64:67], v99
    ds_read_b128 v[68:71], v99 offset:1152
    s_waitcnt lgkmcnt(1)
    buffer_store_dwordx4 v[64:67], v100, s[16:19], 0 offen sc0 sc1
    s_waitcnt lgkmcnt(0)
    buffer_store_dwordx4 v[68:71], v100, s[16:19], s34 offen sc0 sc1
    s_add_u32 s34, s22, 16384
    buffer_load_dwordx4 v[32:35], v97, s[8:11], s34 offen sc1
    s_waitcnt vmcnt(10) lgkmcnt(0)
    v_mfma_f32_16x16x32_bf16 v[64:67], v[104:107], v[0:3], 0
    v_mfma_f32_16x16x32_bf16 v[68:71], v[108:111], v[0:3], 0
    v_mfma_f32_16x16x32_bf16 v[72:75], v[112:115], v[0:3], 0
    v_mfma_f32_16x16x32_bf16 v[76:79], v[116:119], v[0:3], 0
    ds_read_b64_tr_b16 v[104:105], v88 offset:28672
    ds_read_b64_tr_b16 v[106:107], v88 offset:29696
    ds_read_b64_tr_b16 v[108:109], v89 offset:28672
    ds_read_b64_tr_b16 v[110:111], v89 offset:29696
    ds_read_b64_tr_b16 v[112:113], v90 offset:28672
    ds_read_b64_tr_b16 v[114:115], v90 offset:29696
    ds_read_b64_tr_b16 v[116:117], v91 offset:28672
    ds_read_b64_tr_b16 v[118:119], v91 offset:29696
    s_add_u32 s34, s22, 18432
    buffer_load_dwordx4 v[36:39], v97, s[8:11], s34 offen sc1
    s_waitcnt vmcnt(10)
    v_mfma_f32_16x16x32_bf16 v[64:67], v[120:123], v[4:7], v[64:67]
    v_mfma_f32_16x16x32_bf16 v[68:71], v[124:127], v[4:7], v[68:71]
    v_mfma_f32_16x16x32_bf16 v[72:75], v[128:131], v[4:7], v[72:75]
    v_mfma_f32_16x16x32_bf16 v[76:79], v[132:135], v[4:7], v[76:79]
    s_waitcnt lgkmcnt(4)
    ds_read_b64_tr_b16 v[120:121], v90 offset:32256
    ds_read_b64_tr_b16 v[122:123], v90 offset:33280
    ds_read_b64_tr_b16 v[124:125], v91 offset:32256
    ds_read_b64_tr_b16 v[126:127], v91 offset:33280
    ds_read_b64_tr_b16 v[128:129], v88 offset:32256
    ds_read_b64_tr_b16 v[130:131], v88 offset:33280
    ds_read_b64_tr_b16 v[132:133], v89 offset:32256
    ds_read_b64_tr_b16 v[134:135], v89 offset:33280
    s_add_u32 s34, s22, 20480
    buffer_load_dwordx4 v[40:43], v97, s[8:11], s34 offen sc1
    s_waitcnt vmcnt(10)
    v_mfma_f32_16x16x32_bf16 v[64:67], v[136:139], v[8:11], v[64:67]
    v_mfma_f32_16x16x32_bf16 v[68:71], v[140:143], v[8:11], v[68:71]
    v_mfma_f32_16x16x32_bf16 v[72:75], v[144:147], v[8:11], v[72:75]
    v_mfma_f32_16x16x32_bf16 v[76:79], v[148:151], v[8:11], v[76:79]
    s_waitcnt lgkmcnt(4)
    ds_read_b64_tr_b16 v[136:137], v88 offset:35840
    ds_read_b64_tr_b16 v[138:139], v88 offset:36864
    ds_read_b64_tr_b16 v[140:141], v89 offset:35840
    ds_read_b64_tr_b16 v[142:143], v89 offset:36864
    ds_read_b64_tr_b16 v[144:145], v90 offset:35840
    ds_read_b64_tr_b16 v[146:147], v90 offset:36864
    ds_read_b64_tr_b16 v[148:149], v91 offset:35840
    ds_read_b64_tr_b16 v[150:151], v91 offset:36864
    s_add_u32 s34, s22, 22528
    buffer_load_dwordx4 v[44:47], v97, s[8:11], s34 offen sc1
    s_waitcnt vmcnt(10)
    v_mfma_f32_16x16x32_bf16 v[64:67], v[152:155], v[12:15], v[64:67]
    v_mfma_f32_16x16x32_bf16 v[68:71], v[156:159], v[12:15], v[68:71]
    v_mfma_f32_16x16x32_bf16 v[72:75], v[160:163], v[12:15], v[72:75]
    v_mfma_f32_16x16x32_bf16 v[76:79], v[164:167], v[12:15], v[76:79]
    s_waitcnt lgkmcnt(4)
    ds_read_b64_tr_b16 v[152:153], v90 offset:39424
    ds_read_b64_tr_b16 v[154:155], v90 offset:40448
    ds_read_b64_tr_b16 v[156:157], v91 offset:39424
    ds_read_b64_tr_b16 v[158:159], v91 offset:40448
    ds_read_b64_tr_b16 v[160:161], v88 offset:39424
    ds_read_b64_tr_b16 v[162:163], v88 offset:40448
    ds_read_b64_tr_b16 v[164:165], v89 offset:39424
    ds_read_b64_tr_b16 v[166:167], v89 offset:40448
    s_add_u32 s34, s22, 24576
    buffer_load_dwordx4 v[48:51], v97, s[8:11], s34 offen sc1
    s_waitcnt vmcnt(10)
    v_mfma_f32_16x16x32_bf16 v[64:67], v[168:171], v[16:19], v[64:67]
    v_mfma_f32_16x16x32_bf16 v[68:71], v[172:175], v[16:19], v[68:71]
    v_mfma_f32_16x16x32_bf16 v[72:75], v[176:179], v[16:19], v[72:75]
    v_mfma_f32_16x16x32_bf16 v[76:79], v[180:183], v[16:19], v[76:79]
    s_waitcnt lgkmcnt(4)
    ds_read_b64_tr_b16 v[168:169], v88 offset:43008
    ds_read_b64_tr_b16 v[170:171], v88 offset:44032
    ds_read_b64_tr_b16 v[172:173], v89 offset:43008
    ds_read_b64_tr_b16 v[174:175], v89 offset:44032
    ds_read_b64_tr_b16 v[176:177], v90 offset:43008
    ds_read_b64_tr_b16 v[178:179], v90 offset:44032
    ds_read_b64_tr_b16 v[180:181], v91 offset:43008
    ds_read_b64_tr_b16 v[182:183], v91 offset:44032
    s_add_u32 s34, s22, 26624
    buffer_load_dwordx4 v[52:55], v97, s[8:11], s34 offen sc1
    s_waitcnt vmcnt(10)
    v_mfma_f32_16x16x32_bf16 v[64:67], v[184:187], v[20:23], v[64:67]
    v_mfma_f32_16x16x32_bf16 v[68:71], v[188:191], v[20:23], v[68:71]
    v_mfma_f32_16x16x32_bf16 v[72:75], v[192:195], v[20:23], v[72:75]
    v_mfma_f32_16x16x32_bf16 v[76:79], v[196:199], v[20:23], v[76:79]
    s_waitcnt lgkmcnt(4)
    ds_read_b64_tr_b16 v[184:185], v90 offset:46592
    ds_read_b64_tr_b16 v[186:187], v90 offset:47616
    ds_read_b64_tr_b16 v[188:189], v91 offset:46592
    ds_read_b64_tr_b16 v[190:191], v91 offset:47616
    ds_read_b64_tr_b16 v[192:193], v88 offset:46592
    ds_read_b64_tr_b16 v[194:195], v88 offset:47616
    ds_read_b64_tr_b16 v[196:197], v89 offset:46592
    ds_read_b64_tr_b16 v[198:199], v89 offset:47616
    s_add_u32 s34, s22, 28672
    buffer_load_dwordx4 v[56:59], v97, s[8:11], s34 offen sc1
    s_waitcnt vmcnt(10)
    v_mfma_f32_16x16x32_bf16 v[64:67], v[200:203], v[24:27], v[64:67]
    v_mfma_f32_16x16x32_bf16 v[68:71], v[204:207], v[24:27], v[68:71]
    v_mfma_f32_16x16x32_bf16 v[72:75], v[208:211], v[24:27], v[72:75]
    v_mfma_f32_16x16x32_bf16 v[76:79], v[212:215], v[24:27], v[76:79]
    s_waitcnt lgkmcnt(4)
    ds_read_b64_tr_b16 v[200:201], v88 offset:50176
    ds_read_b64_tr_b16 v[202:203], v88 offset:51200
    ds_read_b64_tr_b16 v[204:205], v89 offset:50176
    ds_read_b64_tr_b16 v[206:207], v89 offset:51200
    ds_read_b64_tr_b16 v[208:209], v90 offset:50176
    ds_read_b64_tr_b16 v[210:211], v90 offset:51200
    ds_read_b64_tr_b16 v[212:213], v91 offset:50176
    ds_read_b64_tr_b16 v[214:215], v91 offset:51200
    s_add_u32 s34, s22, 30720
    buffer_load_dwordx4 v[60:63], v97, s[8:11], s34 offen sc1
    s_waitcnt vmcnt(10)
    v_mfma_f32_16x16x32_bf16 v[64:67], v[216:219], v[28:31], v[64:67]
    v_mfma_f32_16x16x32_bf16 v[68:71], v[220:223], v[28:31], v[68:71]
    v_mfma_f32_16x16x32_bf16 v[72:75], v[224:227], v[28:31], v[72:75]
    v_mfma_f32_16x16x32_bf16 v[76:79], v[228:231], v[28:31], v[76:79]
    s_waitcnt lgkmcnt(4)
    ds_read_b64_tr_b16 v[216:217], v90 offset:53760
    ds_read_b64_tr_b16 v[218:219], v94 offset:54784
    ds_read_b64_tr_b16 v[220:221], v91 offset:53760
    ds_read_b64_tr_b16 v[222:223], v95 offset:54784
    ds_read_b64_tr_b16 v[224:225], v88 offset:53760
    ds_read_b64_tr_b16 v[226:227], v92 offset:54784
    ds_read_b64_tr_b16 v[228:229], v89 offset:53760
    ds_read_b64_tr_b16 v[230:231], v93 offset:54784
    s_waitcnt vmcnt(7) lgkmcnt(7)
    v_mfma_f32_16x16x32_bf16 v[64:67], v[104:107], v[32:35], v[64:67]
    v_mfma_f32_16x16x32_bf16 v[68:71], v[108:111], v[32:35], v[68:71]
    v_mfma_f32_16x16x32_bf16 v[72:75], v[112:115], v[32:35], v[72:75]
    v_mfma_f32_16x16x32_bf16 v[76:79], v[116:119], v[32:35], v[76:79]
    s_waitcnt vmcnt(6) lgkmcnt(7)
    v_mfma_f32_16x16x32_bf16 v[64:67], v[120:123], v[36:39], v[64:67]
    v_mfma_f32_16x16x32_bf16 v[68:71], v[124:127], v[36:39], v[68:71]
    v_mfma_f32_16x16x32_bf16 v[72:75], v[128:131], v[36:39], v[72:75]
    v_mfma_f32_16x16x32_bf16 v[76:79], v[132:135], v[36:39], v[76:79]
    s_waitcnt vmcnt(5) lgkmcnt(7)
    v_mfma_f32_16x16x32_bf16 v[64:67], v[136:139], v[40:43], v[64:67]
    v_mfma_f32_16x16x32_bf16 v[68:71], v[140:143], v[40:43], v[68:71]
    v_mfma_f32_16x16x32_bf16 v[72:75], v[144:147], v[40:43], v[72:75]
    v_mfma_f32_16x16x32_bf16 v[76:79], v[148:151], v[40:43], v[76:79]
    s_waitcnt vmcnt(4) lgkmcnt(7)
    v_mfma_f32_16x16x32_bf16 v[64:67], v[152:155], v[44:47], v[64:67]
    v_mfma_f32_16x16x32_bf16 v[68:71], v[156:159], v[44:47], v[68:71]
    v_mfma_f32_16x16x32_bf16 v[72:75], v[160:163], v[44:47], v[72:75]
    v_mfma_f32_16x16x32_bf16 v[76:79], v[164:167], v[44:47], v[76:79]
    s_waitcnt vmcnt(3) lgkmcnt(7)
    v_mfma_f32_16x16x32_bf16 v[64:67], v[168:171], v[48:51], v[64:67]
    v_mfma_f32_16x16x32_bf16 v[68:71], v[172:175], v[48:51], v[68:71]
    v_mfma_f32_16x16x32_bf16 v[72:75], v[176:179], v[48:51], v[72:75]
    v_mfma_f32_16x16x32_bf16 v[76:79], v[180:183], v[48:51], v[76:79]
    s_waitcnt vmcnt(2) lgkmcnt(7)
    v_mfma_f32_16x16x32_bf16 v[64:67], v[184:187], v[52:55], v[64:67]
    v_mfma_f32_16x16x32_bf16 v[68:71], v[188:191], v[52:55], v[68:71]
    v_mfma_f32_16x16x32_bf16 v[72:75], v[192:195], v[52:55], v[72:75]
    v_mfma_f32_16x16x32_bf16 v[76:79], v[196:199], v[52:55], v[76:79]
    s_waitcnt vmcnt(1) lgkmcnt(7)
    v_mfma_f32_16x16x32_bf16 v[64:67], v[200:203], v[56:59], v[64:67]
    v_mfma_f32_16x16x32_bf16 v[68:71], v[204:207], v[56:59], v[68:71]
    v_mfma_f32_16x16x32_bf16 v[72:75], v[208:211], v[56:59], v[72:75]
    v_mfma_f32_16x16x32_bf16 v[76:79], v[212:215], v[56:59], v[76:79]
    s_waitcnt vmcnt(0) lgkmcnt(0)
    v_mfma_f32_16x16x32_bf16 v[64:67], v[216:219], v[60:63], v[64:67]
    v_mfma_f32_16x16x32_bf16 v[68:71], v[220:223], v[60:63], v[68:71]
    v_mfma_f32_16x16x32_bf16 v[72:75], v[224:227], v[60:63], v[72:75]
    v_mfma_f32_16x16x32_bf16 v[76:79], v[228:231], v[60:63], v[76:79]
    s_nop 4
    v_cvt_pk_bf16_f32 v80, v64, v65
    v_cvt_pk_bf16_f32 v81, v66, v67
    v_cvt_pk_bf16_f32 v82, v68, v69
    v_cvt_pk_bf16_f32 v83, v70, v71
    v_cvt_pk_bf16_f32 v84, v72, v73
    v_cvt_pk_bf16_f32 v85, v74, v75
    v_cvt_pk_bf16_f32 v86, v76, v77
    v_cvt_pk_bf16_f32 v87, v78, v79
    ds_write_b64 v98, v[80:81] offset:0
    ds_write_b64 v98, v[82:83] offset:32
    ds_write_b64 v98, v[84:85] offset:64
    ds_write_b64 v98, v[86:87] offset:96
    s_movk_i32 s34, 14336
    s_waitcnt lgkmcnt(0)
    ds_read_b128 v[64:67], v99
    ds_read_b128 v[68:71], v99 offset:1152
    s_waitcnt lgkmcnt(1)
    buffer_store_dwordx4 v[64:67], v101, s[16:19], 0 offen sc0 sc1
    s_waitcnt lgkmcnt(0)
    buffer_store_dwordx4 v[68:71], v101, s[16:19], s34 offen sc0 sc1
L_k2_end:
    s_endpgm
L_k2_code_end:
.section .rodata,"a"
.p2align 6
.amdhsa_kernel attn_kernel
  .amdhsa_next_free_vgpr 252
  .amdhsa_next_free_sgpr 102
  .amdhsa_accum_offset 252
  .amdhsa_group_segment_fixed_size 0
  .amdhsa_kernarg_size 72
  .amdhsa_user_sgpr_count 2
  .amdhsa_user_sgpr_kernarg_segment_ptr 1
  .amdhsa_system_sgpr_workgroup_id_x 1
.end_amdhsa_kernel
```
